```python
import torch

def _softmax(x, axis=-1):
    return torch.softmax(x, dim=axis)
def _gelu(x):
    return torch.nn.functional.gelu(x, approximate="tanh")
def _silu(x):
    return torch.nn.functional.silu(x)
def _sigmoid(x):
    return torch.sigmoid(x)
def _layernorm(x, axis=-1, eps=1e-5):
    m = x.mean(dim=axis, keepdim=True)
    v = x.var(dim=axis, keepdim=True, unbiased=False)
    return (x - m) / torch.sqrt(v + eps)
def _scatter_add(tgt, idx, src, axis=0):
    return tgt.clone().index_add_(axis, idx, src)
def _segment_sum(src, seg, n):
    out = torch.zeros((n,) + src.shape[1:], dtype=src.dtype)
    return out.index_add_(0, seg, src)
def _pad(x, pw):
    flat = tuple(v for pair in reversed(pw) for v in pair)
    return torch.nn.functional.pad(x, flat)

kernel_name = 'gated_mix__ssm_conv_s4__swiglu_ffn__prompt'

def setup_inputs():

    _w = (lambda a: (lambda t: t.to(torch.bfloat16) if t.is_floating_point() else t)(torch.as_tensor(a)))
    def _A_setup():
        B, L, D, N = 1, 2048, 448, 256
        A_re = -(lambda _x: torch.exp(torch.as_tensor(_x)))((lambda *s: torch.randn(*s, dtype=torch.bfloat16) * 3.2)(D, N))
        A_im = torch.pi * (lambda *s: torch.randn(*s, dtype=torch.bfloat16) * 0.05)(D, N)
        B_re = (lambda *s: torch.randn(*s, dtype=torch.bfloat16) * 0.05)(D, N)
        B_im = (lambda *s: torch.randn(*s, dtype=torch.bfloat16) * 0.05)(D, N)
        C_re = (lambda *s: torch.randn(*s, dtype=torch.bfloat16) * 0.1)(D, N)
        C_im = (lambda *s: torch.randn(*s, dtype=torch.bfloat16) * 0.1)(D, N)
        log_dt = (lambda *s: torch.randn(*s, dtype=torch.bfloat16) * 0.05)(D) * 0.5 - 4.0
        Dskip = (lambda *s: torch.randn(*s, dtype=torch.bfloat16) * 0.05)(D)
        return {
            "u": _w((lambda *s: torch.randn(*s, dtype=torch.bfloat16) * 0.05)(B, L, D)),
            "A_re": _w(A_re),
            "A_im": _w(A_im),
            "B_re": _w(B_re),
            "B_im": _w(B_im),
            "C_re": _w(C_re),
            "C_im": _w(C_im),
            "log_dt": _w(log_dt),
            "Dskip": _w(Dskip),
        }
    _A_in = _A_setup()

    def _B_setup():
        B, S, D, F = 1, 2048, 448, 1792
        return {
            "x": _w((lambda *s: torch.randn(*s, dtype=torch.bfloat16) * 0.05)(B, S, D)),
            "w_gate": _w((lambda *s: torch.randn(*s, dtype=torch.bfloat16) * 0.05)(D, F)),
            "w_up": _w((lambda *s: torch.randn(*s, dtype=torch.bfloat16) * 0.05)(D, F)),
            "w_down": _w((lambda *s: torch.randn(*s, dtype=torch.bfloat16) * 0.05)(F, D)),
        }
    _B_in = _B_setup()

    return {
        "A_u": _A_in["u"],
        "A_A_re": _A_in["A_re"],
        "A_A_im": _A_in["A_im"],
        "A_B_re": _A_in["B_re"],
        "A_B_im": _A_in["B_im"],
        "A_C_re": _A_in["C_re"],
        "A_C_im": _A_in["C_im"],
        "A_log_dt": _A_in["log_dt"],
        "A_Dskip": _A_in["Dskip"],
        "B_x": _B_in["x"],
        "B_w_gate": _B_in["w_gate"],
        "B_w_up": _B_in["w_up"],
        "B_w_down": _B_in["w_down"],
        "gate_w": _w((lambda *s: torch.randn(*s, dtype=torch.bfloat16) * 0.05)(448) * 16.0),
    }

def reference(A_u, A_A_re, A_A_im, A_B_re, A_B_im, A_C_re, A_C_im, A_log_dt, A_Dskip, B_x, B_w_gate, B_w_up, B_w_down, gate_w):
    def _A_ref(u, A_re, A_im, B_re, B_im, C_re, C_im, log_dt, Dskip):
        Bsz, L, D = u.shape
        dt = torch.exp(log_dt)[:, None]
        A = A_re + 1j * A_im
        Bc = B_re + 1j * B_im
        Cc = C_re + 1j * C_im
        logdA = dt * A
        dB = dt * Bc
        l = (lambda x, dt: x.to(dt))(torch.arange(L), A_re.dtype)
        P = torch.exp(logdA[:, :, None] * l[None, None, :])
        K = torch.einsum("dn,dnl,dn->dl", Cc, P, dB).real
        L2 = 2 * L
        Kp = _pad(K, ((0, 0), (0, L)))
        up = (lambda x, *d: x.permute(*d))(u, 0, 2, 1)
        up = _pad(up, ((0, 0), (0, 0), (0, L)))
        Kf = (lambda x, axes=(-2,-1): torch.fft.rfft2(x.float(), dim=axes))(Kp[:, None, :], axes=(-2, -1))
        Uf = (lambda x, axes=(-2,-1): torch.fft.rfft2(x.float(), dim=axes))(up[:, :, None, :], axes=(-2, -1))
        Yf = Uf * Kf[None, :, :, :]
        y = (lambda x, s, axes=(-2,-1): torch.fft.irfft2(x, s=s, dim=axes).to(torch.bfloat16))(Yf, (1, L2), axes=(-2, -1))[:, :, 0, :L]
        y = (lambda x, *d: x.permute(*d))(y, 0, 2, 1) + u * Dskip[None, None, :]
        return y

    def _B_ref(x, w_gate, w_up, w_down):
        g = _silu(x @ w_gate)
        u = x @ w_up
        return (g * u) @ w_down

    x = A_u
    g = _sigmoid((x * gate_w).sum(-1, keepdims=True))
    a = _A_ref(x, A_A_re, A_A_im, A_B_re, A_B_im, A_C_re, A_C_im, A_log_dt, A_Dskip)
    b = _B_ref(x, B_w_gate, B_w_up, B_w_down)
    return g * a + (1 - g) * b
```

```asm
; @launch grid=(480,1,1) block=(256,1,1) lds=81920
.amdgcn_target "amdgcn-amd-amdhsa--gfx950"
.text
.globl gated_mix__ssm_conv_s4__swiglu_ffn__prompt_kernel
.p2align 8
.type gated_mix__ssm_conv_s4__swiglu_ffn__prompt_kernel,@function
gated_mix__ssm_conv_s4__swiglu_ffn__prompt_kernel:
    s_cmp_ge_u32 s2, 480
    s_cbranch_scc1 L_end
    s_load_dwordx16 s[4:19], s[0:1], 0
    s_load_dwordx16 s[20:35], s[0:1], 64
    s_load_dwordx2 s[36:37], s[0:1], 128
    v_lshrrev_b32 v1, 6, v0
    v_and_b32 v0, 63, v0
    v_readfirstlane_b32 s60, v1
    s_and_b32 s66, s2, 7
    s_bfe_u32 s67, s2, 0x50003
    s_and_b32 s72, s66, 3
    s_lshl_b32 s72, s72, 3
    s_lshr_b32 s73, s66, 2
    s_lshl_b32 s73, s73, 2
    s_add_u32 s72, s72, s73
    s_and_b32 s73, s67, 3
    s_add_u32 s64, s72, s73
    s_lshr_b32 s65, s67, 2
    s_lshl_b32 s82, s60, 12
    s_cmp_ge_u32 s2, 256
    s_cbranch_scc1 L_ssm
    s_cmp_ge_u32 s2, 224
    s_cbranch_scc1 L_aux
L_gemm:
    s_setprio 1
    s_and_b32 s72, s66, 3
    s_lshl_b32 s72, s72, 2
    s_and_b32 s73, s67, 3
    s_add_u32 s61, s72, s73
    s_lshr_b32 s72, s66, 2
    s_mul_i32 s72, s72, 7
    s_add_u32 s62, s72, s65
    s_and_b32 s72, s67, 3
    s_add_u32 s72, s72, s65
    s_mul_i32 s72, s72, 3
    s_lshr_b32 s72, 280038160, s72
    s_and_b32 s74, s72, 7
    s_lshl_b32 s78, s74, 7
    s_mul_i32 s79, s74, 229376
    s_lshl_b32 s72, s61, 2
    s_add_u32 s72, s72, s60
    s_mul_i32 s83, s72, 28672
    s_and_b32 s73, s60, 1
    s_mul_i32 s73, s73, 114688
    s_lshl_b32 s84, s62, 8
    s_add_u32 s84, s84, s73
    v_lshrrev_b32 v1, 3, v0
    v_and_b32 v232, 7, v0
    v_lshrrev_b32 v233, 1, v1
    v_and_b32 v234, 1, v233
    v_lshlrev_b32 v234, 2, v234
    v_xor_b32 v234, v234, v232
    v_lshlrev_b32 v234, 4, v234
    v_mul_u32_u24 v2, 3584, v1
    v_add_u32 v2, v2, v234
    v_add_u32 v3, 27648, v2
    v_add_u32 v4, 55296, v2
    v_add_u32 v5, 82944, v2
    v_xor_b32 v235, v233, v232
    v_lshlrev_b32 v235, 4, v235
    v_mul_u32_u24 v236, 896, v1
    v_add_u32 v6, v236, v235
    v_xor_b32 v235, 64, v235
    v_add_u32_e64 v237, v236, v235
    v_add_u32 v7, 6144, v237
    v_add_u32 v8, 12288, v6
    v_add_u32 v9, 18432, v237
    v_add_u32 v230, v236, v234
    v_add_u32 v231, 6144, v230
    s_waitcnt lgkmcnt(0)
    s_load_dword s63, s[36:37], 0
    s_mov_b32 s40, s4
    s_mov_b32 s41, s5
    s_mov_b32 s42, 1835008
    s_mov_b32 s43, 0x20000
    s_cmp_lt_u32 s60, 2
    s_cselect_b32 s44, s24, s26
    s_cselect_b32 s45, s25, s27
    s_mov_b32 s46, 1605632
    s_mov_b32 s47, 0x20000
    s_add_u32 s6, s83, s78
    s_add_u32 s13, s84, s79
    s_add_u32 m0, s82, 0
    s_nop 0
    buffer_load_dwordx4 v6, s[40:43], s6 offen offset:0 lds
    buffer_load_dwordx4 v7, s[40:43], s6 offen offset:1024 lds
    buffer_load_dwordx4 v8, s[40:43], s6 offen offset:2048 lds
    buffer_load_dwordx4 v9, s[40:43], s6 offen offset:3072 lds
    s_add_u32 m0, s82, 16384
    s_nop 0
    buffer_load_dwordx4 v2, s[44:47], s13 offen offset:0 lds
    buffer_load_dwordx4 v3, s[44:47], s13 offen offset:1024 lds
    buffer_load_dwordx4 v4, s[44:47], s13 offen offset:2048 lds
    buffer_load_dwordx4 v5, s[44:47], s13 offen offset:3072 lds
    s_add_u32 s72, s78, 128
    s_sub_u32 s73, s72, 896
    s_cselect_b32 s78, s72, s73
    s_add_u32 s72, s79, 229376
    s_sub_u32 s73, s72, 1605632
    s_cselect_b32 s79, s72, s73
    s_add_u32 s7, s83, s78
    s_add_u32 s14, s84, s79
    s_add_u32 s72, s78, 128
    s_sub_u32 s73, s72, 896
    s_cselect_b32 s78, s72, s73
    s_add_u32 s72, s79, 229376
    s_sub_u32 s73, s72, 1605632
    s_cselect_b32 s79, s72, s73
    s_add_u32 s8, s83, s78
    s_add_u32 s15, s84, s79
    s_add_u32 s72, s78, 128
    s_sub_u32 s73, s72, 896
    s_cselect_b32 s78, s72, s73
    s_add_u32 s72, s79, 229376
    s_sub_u32 s73, s72, 1605632
    s_cselect_b32 s79, s72, s73
    s_add_u32 s9, s83, s78
    s_add_u32 s16, s84, s79
    s_add_u32 s72, s78, 128
    s_sub_u32 s73, s72, 896
    s_cselect_b32 s78, s72, s73
    s_add_u32 s72, s79, 229376
    s_sub_u32 s73, s72, 1605632
    s_cselect_b32 s79, s72, s73
    s_add_u32 s10, s83, s78
    s_add_u32 s17, s84, s79
    s_add_u32 s72, s78, 128
    s_sub_u32 s73, s72, 896
    s_cselect_b32 s78, s72, s73
    s_add_u32 s72, s79, 229376
    s_sub_u32 s73, s72, 1605632
    s_cselect_b32 s79, s72, s73
    s_add_u32 s11, s83, s78
    s_add_u32 s18, s84, s79
    s_add_u32 s72, s78, 128
    s_sub_u32 s73, s72, 896
    s_cselect_b32 s78, s72, s73
    s_add_u32 s72, s79, 229376
    s_sub_u32 s73, s72, 1605632
    s_cselect_b32 s79, s72, s73
    s_add_u32 s12, s83, s78
    s_add_u32 s19, s84, s79
    s_mov_b32 s52, s36
    s_mov_b32 s53, s37
    s_mov_b32 s54, 16777216
    s_mov_b32 s55, 0x20000
    s_mov_b32 s48, s28
    s_mov_b32 s49, s29
    s_mov_b32 s50, 1605632
    s_mov_b32 s51, 0x20000
    s_mov_b32 s56, s32
    s_mov_b32 s57, s33
    s_mov_b32 s58, 1835008
    s_mov_b32 s59, 0x20000
    v_and_b32 v232, 31, v0
    v_lshrrev_b32 v233, 5, v0
    v_bfe_u32 v234, v0, 1, 3
    v_xor_b32 v234, v234, v233
    v_lshlrev_b32 v234, 4, v234
    v_lshl_add_u32 v10, v232, 7, v234
    v_add_u32 v10, s82, v10
    v_xor_b32 v11, 32, v10
    v_xor_b32_e64 v12, 64, v10
    v_xor_b32 v13, 96, v10
    v_bfe_u32 v234, v0, 2, 2
    v_lshlrev_b32_e64 v235, 10, v233
    v_lshl_add_u32 v235, v234, 7, v235
    v_bfe_u32 v236, v0, 3, 1
    v_lshl_add_u32 v235, v236, 6, v235
    v_bfe_u32 v236, v0, 4, 1
    v_and_b32_e64 v237, 1, v0
    v_bfe_u32 v238, v0, 1, 1
    v_lshl_add_u32 v239, v238, 3, v235
    v_lshl_add_u32 v224, v236, 5, v239
    v_lshl_add_u32 v224, v237, 4, v224
    v_xor_b32_e64 v225, 64, v224
    v_add_u32 v226, 0x10000, v224
    v_add_u32 v227, 0x10000, v225
    v_lshl_add_u32 v1, v237, 5, v239
    v_lshl_add_u32 v1, v236, 4, v1
    v_add_u32 v1, s82, v1
    s_and_b32 s72, s60, 1
    s_lshl_b32 s72, s72, 6
    v_xor_b32 v1, s72, v1
    v_lshlrev_b32 v14, 4, v0
    s_lshl_b32 s72, s61, 1
    s_lshr_b32 s73, s60, 1
    s_add_u32 s72, s72, s73
    s_mul_i32 s85, s72, 229376
    s_and_b32 s73, s60, 1
    s_lshl_b32 s73, s73, 10
    s_add_u32 s85, s85, s73
    s_lshl_b32 s73, s62, 14
    s_add_u32 s85, s85, s73
    s_add_u32 s85, s85, 5242880
    v_lshrrev_b32 v232, 1, v0
    v_lshlrev_b32 v232, 12, v232
    v_and_b32 v233, 1, v0
    v_lshl_add_u32 v15, v233, 7, v232
    s_lshl_b32 s72, s61, 8
    s_lshl_b32 s73, s62, 2
    s_add_u32 s72, s72, s73
    s_add_u32 s72, s72, 131072
    s_cmp_eq_u32 s60, 0
    s_cselect_b32 s75, 16, 0
    v_add_u32 v15, s72, v15
    v_cmp_gt_u32 vcc, s75, v0
    s_nop 1
    v_cndmask_b32 v15, 2.0, v15, vcc
    s_lshl_b32 s72, s2, 7
    s_add_u32 s72, s72, 229380
    s_cmp_eq_u32 s60, 0
    s_cselect_b32 s72, s72, 2.0
    v_writelane_b32 v15, s72, 16
    s_lshl_b32 s72, s65, 5
    s_add_u32 s72, s72, s64
    s_lshl_b32 s87, s72, 7
    s_mov_b32 s39, 0x8000
    s_mov_b32 s72, s60
    s_mul_i32 s80, s72, 14336
    s_lshl_b32 s73, s65, 7
    s_add_u32 s80, s80, s73
    s_lshl_b32 s81, s72, 11
    s_lshr_b32 s72, s60, 1
    s_lshl_b32 s72, s72, 3
    s_and_b32 s95, s60, 1
    s_add_u32 s72, s72, s95
    s_add_u32 s72, s72, 4
    s_lshl_b32 s95, s72, 11
    s_mul_i32 s96, s72, 14336
    s_add_u32 s96, s96, s73
    s_mul_i32 s72, s64, 229376
    s_add_u32 s72, s72, 5242880
    s_add_u32 s68, s36, s72
    s_addc_u32 s69, s37, 0
    s_mov_b32 s70, 229376
    s_mov_b32 s71, 0x20000
    s_mov_b32 s76, 3216550459
    s_mov_b32 s77, 3216550459
    s_lshl_b32 s72, s64, 1
    s_lshr_b32 s73, s60, 1
    s_add_u32 s72, s72, s73
    s_mul_i32 s99, s72, 28672
    s_lshl_b32 s72, s65, 1
    s_and_b32 s73, s60, 1
    s_add_u32 s72, s72, s73
    s_lshl_b32 s72, s72, 6
    s_add_u32 s99, s99, s72
    s_waitcnt lgkmcnt(0)
    s_mul_i32 s63, s63, 0x9E3779B1
    s_add_u32 s63, s63, 0x7F4A7C15
    s_mov_b32 s88, s63
    s_mov_b32 s89, s63
    v_mov_b32 v228, s63
    s_add_u32 m0, s82, 32768
    s_nop 0
    buffer_load_dwordx4 v6, s[40:43], s7 offen offset:0 lds
    buffer_load_dwordx4 v7, s[40:43], s7 offen offset:1024 lds
    buffer_load_dwordx4 v8, s[40:43], s7 offen offset:2048 lds
    buffer_load_dwordx4 v9, s[40:43], s7 offen offset:3072 lds
    s_add_u32 m0, s82, 49152
    s_nop 0
    buffer_load_dwordx4 v2, s[44:47], s14 offen offset:0 lds
    buffer_load_dwordx4 v3, s[44:47], s14 offen offset:1024 lds
    buffer_load_dwordx4 v4, s[44:47], s14 offen offset:2048 lds
    buffer_load_dwordx4 v5, s[44:47], s14 offen offset:3072 lds
    s_add_u32 m0, s82, 65536
    s_nop 0
    buffer_load_dwordx4 v6, s[40:43], s8 offen offset:0 lds
    buffer_load_dwordx4 v7, s[40:43], s8 offen offset:1024 lds
    buffer_load_dwordx4 v8, s[40:43], s8 offen offset:2048 lds
    buffer_load_dwordx4 v9, s[40:43], s8 offen offset:3072 lds
    s_waitcnt lgkmcnt(0)
    s_waitcnt vmcnt(12)
    s_barrier
    ds_read_b128 v[112:115], v10 offset:0
    ds_read_b64_tr_b16 v[16:17], v224 offset:16384
    ds_read_b64_tr_b16 v[18:19], v224 offset:16896
    ds_read_b64_tr_b16 v[20:21], v225 offset:16384
    ds_read_b64_tr_b16 v[22:23], v225 offset:16896
    ds_read_b64_tr_b16 v[24:25], v224 offset:24576
    ds_read_b64_tr_b16 v[26:27], v224 offset:25088
    ds_read_b128 v[116:119], v11 offset:0
    ds_read_b64_tr_b16 v[28:29], v225 offset:24576
    ds_read_b64_tr_b16 v[30:31], v225 offset:25088
    ds_read_b128 v[120:123], v12 offset:0
    ds_read_b64_tr_b16 v[32:33], v224 offset:18432
    ds_read_b64_tr_b16 v[34:35], v224 offset:18944
    ds_read_b128 v[124:127], v13 offset:0
    ds_read_b64_tr_b16 v[36:37], v225 offset:18432
    ds_read_b64_tr_b16 v[38:39], v225 offset:18944
    ds_read_b64_tr_b16 v[40:41], v224 offset:26624
    ds_read_b64_tr_b16 v[42:43], v224 offset:27136
    s_waitcnt lgkmcnt(13)
    v_mfma_f32_32x32x16_bf16 v[48:63], v[16:19], v[112:115], 0
    ds_read_b64_tr_b16 v[44:45], v225 offset:26624
    ds_read_b64_tr_b16 v[46:47], v225 offset:27136
    v_mfma_f32_32x32x16_bf16 v[64:79], v[20:23], v[112:115], 0
    ds_read_b64_tr_b16 v[16:17], v224 offset:20480
    ds_read_b64_tr_b16 v[18:19], v224 offset:20992
    s_waitcnt lgkmcnt(12)
    v_mfma_f32_32x32x16_bf16 v[80:95], v[24:27], v[112:115], 0
    ds_read_b64_tr_b16 v[20:21], v225 offset:20480
    ds_read_b64_tr_b16 v[22:23], v225 offset:20992
    v_mfma_f32_32x32x16_bf16 v[96:111], v[28:31], v[112:115], 0
    ds_read_b64_tr_b16 v[24:25], v224 offset:28672
    ds_read_b64_tr_b16 v[26:27], v224 offset:29184
    s_waitcnt lgkmcnt(10)
    v_mfma_f32_32x32x16_bf16 v[48:63], v[32:35], v[116:119], v[48:63]
    ds_read_b64_tr_b16 v[28:29], v225 offset:28672
    ds_read_b64_tr_b16 v[30:31], v225 offset:29184
    v_mfma_f32_32x32x16_bf16 v[64:79], v[36:39], v[116:119], v[64:79]
    ds_read_b64_tr_b16 v[32:33], v224 offset:22528
    ds_read_b64_tr_b16 v[34:35], v224 offset:23040
    s_waitcnt lgkmcnt(10)
    v_mfma_f32_32x32x16_bf16 v[80:95], v[40:43], v[116:119], v[80:95]
    s_add_u32 m0, s82, 0
    ds_read_b64_tr_b16 v[36:37], v225 offset:22528
    ds_read_b64_tr_b16 v[38:39], v225 offset:23040
    buffer_load_dwordx4 v2, s[44:47], s15 offen offset:0 lds
    v_mfma_f32_32x32x16_bf16 v[96:111], v[44:47], v[116:119], v[96:111]
    ds_read_b64_tr_b16 v[40:41], v224 offset:30720
    ds_read_b64_tr_b16 v[42:43], v224 offset:31232
    buffer_load_dwordx4 v3, s[44:47], s15 offen offset:1024 lds
    s_waitcnt lgkmcnt(10)
    v_mfma_f32_32x32x16_bf16 v[48:63], v[16:19], v[120:123], v[48:63]
    ds_read_b64_tr_b16 v[44:45], v225 offset:30720
    ds_read_b64_tr_b16 v[46:47], v225 offset:31232
    buffer_load_dwordx4 v4, s[44:47], s15 offen offset:2048 lds
    v_mfma_f32_32x32x16_bf16 v[64:79], v[20:23], v[120:123], v[64:79]
    buffer_load_dwordx4 v5, s[44:47], s15 offen offset:3072 lds
    s_waitcnt lgkmcnt(8)
    v_mfma_f32_32x32x16_bf16 v[80:95], v[24:27], v[120:123], v[80:95]
    s_waitcnt lgkmcnt(0)
    s_waitcnt vmcnt(8)
    s_barrier
    ds_read_b128 v[128:131], v10 offset:32768
    ds_read_b64_tr_b16 v[16:17], v224 offset:49152
    ds_read_b64_tr_b16 v[18:19], v224 offset:49664
    ds_read_b64_tr_b16 v[20:21], v225 offset:49152
    ds_read_b64_tr_b16 v[22:23], v225 offset:49664
    v_mfma_f32_32x32x16_bf16 v[96:111], v[28:31], v[120:123], v[96:111]
    ds_read_b64_tr_b16 v[24:25], v224 offset:57344
    ds_read_b64_tr_b16 v[26:27], v224 offset:57856
    ds_read_b128 v[132:135], v11 offset:32768
    v_mfma_f32_32x32x16_bf16 v[48:63], v[32:35], v[124:127], v[48:63]
    s_add_u32 m0, s82, 16384
    ds_read_b64_tr_b16 v[28:29], v225 offset:57344
    ds_read_b64_tr_b16 v[30:31], v225 offset:57856
    ds_read_b128 v[136:139], v12 offset:32768
    buffer_load_dwordx4 v6, s[40:43], s9 offen offset:0 lds
    v_mfma_f32_32x32x16_bf16 v[64:79], v[36:39], v[124:127], v[64:79]
    ds_read_b64_tr_b16 v[32:33], v224 offset:51200
    ds_read_b64_tr_b16 v[34:35], v224 offset:51712
    ds_read_b128 v[140:143], v13 offset:32768
    v_mfma_f32_32x32x16_bf16 v[80:95], v[40:43], v[124:127], v[80:95]
    ds_read_b64_tr_b16 v[36:37], v225 offset:51200
    ds_read_b64_tr_b16 v[38:39], v225 offset:51712
    buffer_load_dwordx4 v7, s[40:43], s9 offen offset:1024 lds
    v_mfma_f32_32x32x16_bf16 v[96:111], v[44:47], v[124:127], v[96:111]
    ds_read_b64_tr_b16 v[40:41], v224 offset:59392
    ds_read_b64_tr_b16 v[42:43], v224 offset:59904
    s_waitcnt lgkmcnt(13)
    v_mfma_f32_32x32x16_bf16 v[48:63], v[16:19], v[128:131], v[48:63]
    ds_read_b64_tr_b16 v[44:45], v225 offset:59392
    ds_read_b64_tr_b16 v[46:47], v225 offset:59904
    v_mfma_f32_32x32x16_bf16 v[64:79], v[20:23], v[128:131], v[64:79]
    ds_read_b64_tr_b16 v[16:17], v224 offset:53248
    ds_read_b64_tr_b16 v[18:19], v224 offset:53760
    buffer_load_dwordx4 v8, s[40:43], s9 offen offset:2048 lds
    s_waitcnt lgkmcnt(12)
    v_mfma_f32_32x32x16_bf16 v[80:95], v[24:27], v[128:131], v[80:95]
    ds_read_b64_tr_b16 v[20:21], v225 offset:53248
    ds_read_b64_tr_b16 v[22:23], v225 offset:53760
    v_mfma_f32_32x32x16_bf16 v[96:111], v[28:31], v[128:131], v[96:111]
    ds_read_b64_tr_b16 v[24:25], v224 offset:61440
    ds_read_b64_tr_b16 v[26:27], v224 offset:61952
    buffer_load_dwordx4 v9, s[40:43], s9 offen offset:3072 lds
    s_waitcnt lgkmcnt(10)
    v_mfma_f32_32x32x16_bf16 v[48:63], v[32:35], v[132:135], v[48:63]
    ds_read_b64_tr_b16 v[28:29], v225 offset:61440
    ds_read_b64_tr_b16 v[30:31], v225 offset:61952
    v_mfma_f32_32x32x16_bf16 v[64:79], v[36:39], v[132:135], v[64:79]
    ds_read_b64_tr_b16 v[32:33], v224 offset:55296
    ds_read_b64_tr_b16 v[34:35], v224 offset:55808
    s_waitcnt lgkmcnt(10)
    v_mfma_f32_32x32x16_bf16 v[80:95], v[40:43], v[132:135], v[80:95]
    s_add_u32 m0, s82, 32768
    ds_read_b64_tr_b16 v[36:37], v225 offset:55296
    ds_read_b64_tr_b16 v[38:39], v225 offset:55808
    buffer_load_dwordx4 v2, s[44:47], s16 offen offset:0 lds
    v_mfma_f32_32x32x16_bf16 v[96:111], v[44:47], v[132:135], v[96:111]
    ds_read_b64_tr_b16 v[40:41], v224 offset:63488
    ds_read_b64_tr_b16 v[42:43], v224 offset:64000
    buffer_load_dwordx4 v3, s[44:47], s16 offen offset:1024 lds
    s_waitcnt lgkmcnt(10)
    v_mfma_f32_32x32x16_bf16 v[48:63], v[16:19], v[136:139], v[48:63]
    ds_read_b64_tr_b16 v[44:45], v225 offset:63488
    ds_read_b64_tr_b16 v[46:47], v225 offset:64000
    buffer_load_dwordx4 v4, s[44:47], s16 offen offset:2048 lds
    v_mfma_f32_32x32x16_bf16 v[64:79], v[20:23], v[136:139], v[64:79]
    buffer_load_dwordx4 v5, s[44:47], s16 offen offset:3072 lds
    s_waitcnt lgkmcnt(8)
    v_mfma_f32_32x32x16_bf16 v[80:95], v[24:27], v[136:139], v[80:95]
    s_waitcnt lgkmcnt(0)
    s_waitcnt vmcnt(8)
    s_barrier
    v_add_u32 v232, 0x10000, v10
    ds_read_b128 v[144:147], v232
    ds_read_b64_tr_b16 v[16:17], v224 offset:0
    ds_read_b64_tr_b16 v[18:19], v224 offset:512
    ds_read_b64_tr_b16 v[20:21], v225 offset:0
    ds_read_b64_tr_b16 v[22:23], v225 offset:512
    v_mfma_f32_32x32x16_bf16 v[96:111], v[28:31], v[136:139], v[96:111]
    ds_read_b64_tr_b16 v[24:25], v224 offset:8192
    ds_read_b64_tr_b16 v[26:27], v224 offset:8704
    v_add_u32 v233, 0x10000, v11
    ds_read_b128 v[148:151], v233
    v_mfma_f32_32x32x16_bf16 v[48:63], v[32:35], v[140:143], v[48:63]
    s_add_u32 m0, s82, 49152
    ds_read_b64_tr_b16 v[28:29], v225 offset:8192
    ds_read_b64_tr_b16 v[30:31], v225 offset:8704
    v_add_u32 v234, 0x10000, v12
    ds_read_b128 v[152:155], v234
    buffer_load_dwordx4 v6, s[40:43], s10 offen offset:0 lds
    v_mfma_f32_32x32x16_bf16 v[64:79], v[36:39], v[140:143], v[64:79]
    ds_read_b64_tr_b16 v[32:33], v224 offset:2048
    ds_read_b64_tr_b16 v[34:35], v224 offset:2560
    v_add_u32 v235, 0x10000, v13
    ds_read_b128 v[156:159], v235
    v_mfma_f32_32x32x16_bf16 v[80:95], v[40:43], v[140:143], v[80:95]
    ds_read_b64_tr_b16 v[36:37], v225 offset:2048
    ds_read_b64_tr_b16 v[38:39], v225 offset:2560
    buffer_load_dwordx4 v7, s[40:43], s10 offen offset:1024 lds
    v_mfma_f32_32x32x16_bf16 v[96:111], v[44:47], v[140:143], v[96:111]
    ds_read_b64_tr_b16 v[40:41], v224 offset:10240
    ds_read_b64_tr_b16 v[42:43], v224 offset:10752
    s_waitcnt lgkmcnt(13)
    v_mfma_f32_32x32x16_bf16 v[48:63], v[16:19], v[144:147], v[48:63]
    ds_read_b64_tr_b16 v[44:45], v225 offset:10240
    ds_read_b64_tr_b16 v[46:47], v225 offset:10752
    v_mfma_f32_32x32x16_bf16 v[64:79], v[20:23], v[144:147], v[64:79]
    ds_read_b64_tr_b16 v[16:17], v224 offset:4096
    ds_read_b64_tr_b16 v[18:19], v224 offset:4608
    buffer_load_dwordx4 v8, s[40:43], s10 offen offset:2048 lds
    s_waitcnt lgkmcnt(12)
    v_mfma_f32_32x32x16_bf16 v[80:95], v[24:27], v[144:147], v[80:95]
    ds_read_b64_tr_b16 v[20:21], v225 offset:4096
    ds_read_b64_tr_b16 v[22:23], v225 offset:4608
    v_mfma_f32_32x32x16_bf16 v[96:111], v[28:31], v[144:147], v[96:111]
    ds_read_b64_tr_b16 v[24:25], v224 offset:12288
    ds_read_b64_tr_b16 v[26:27], v224 offset:12800
    buffer_load_dwordx4 v9, s[40:43], s10 offen offset:3072 lds
    s_waitcnt lgkmcnt(10)
    v_mfma_f32_32x32x16_bf16 v[48:63], v[32:35], v[148:151], v[48:63]
    ds_read_b64_tr_b16 v[28:29], v225 offset:12288
    ds_read_b64_tr_b16 v[30:31], v225 offset:12800
    v_mfma_f32_32x32x16_bf16 v[64:79], v[36:39], v[148:151], v[64:79]
    ds_read_b64_tr_b16 v[32:33], v224 offset:6144
    ds_read_b64_tr_b16 v[34:35], v224 offset:6656
    s_waitcnt lgkmcnt(10)
    v_mfma_f32_32x32x16_bf16 v[80:95], v[40:43], v[148:151], v[80:95]
    s_add_u32 m0, s82, 65536
    ds_read_b64_tr_b16 v[36:37], v225 offset:6144
    ds_read_b64_tr_b16 v[38:39], v225 offset:6656
    buffer_load_dwordx4 v2, s[44:47], s17 offen offset:0 lds
    v_mfma_f32_32x32x16_bf16 v[96:111], v[44:47], v[148:151], v[96:111]
    ds_read_b64_tr_b16 v[40:41], v224 offset:14336
    ds_read_b64_tr_b16 v[42:43], v224 offset:14848
    buffer_load_dwordx4 v3, s[44:47], s17 offen offset:1024 lds
    s_waitcnt lgkmcnt(10)
    v_mfma_f32_32x32x16_bf16 v[48:63], v[16:19], v[152:155], v[48:63]
    ds_read_b64_tr_b16 v[44:45], v225 offset:14336
    ds_read_b64_tr_b16 v[46:47], v225 offset:14848
    buffer_load_dwordx4 v4, s[44:47], s17 offen offset:2048 lds
    v_mfma_f32_32x32x16_bf16 v[64:79], v[20:23], v[152:155], v[64:79]
    buffer_load_dwordx4 v5, s[44:47], s17 offen offset:3072 lds
    v_mov_b32 v255, 0
    s_lshl_b32 s72, s2, 7
    s_add_u32 s72, s72, 229376
    s_cmp_eq_u32 s60, 0
    s_cselect_b32 s75, 1, 0
    v_add_u32 v255, s72, v255
    v_cmp_gt_u32 vcc, s75, v0
    s_nop 1
    v_cndmask_b32 v255, 2.0, v255, vcc
    s_waitcnt lgkmcnt(8)
    v_mfma_f32_32x32x16_bf16 v[80:95], v[24:27], v[152:155], v[80:95]
    s_waitcnt lgkmcnt(0)
    s_waitcnt vmcnt(8)
    s_barrier
    ds_read_b128 v[160:163], v10 offset:16384
    ds_read_b64_tr_b16 v[16:17], v224 offset:32768
    ds_read_b64_tr_b16 v[18:19], v224 offset:33280
    ds_read_b64_tr_b16 v[20:21], v225 offset:32768
    ds_read_b64_tr_b16 v[22:23], v225 offset:33280
    v_mfma_f32_32x32x16_bf16 v[96:111], v[28:31], v[152:155], v[96:111]
    ds_read_b64_tr_b16 v[24:25], v224 offset:40960
    ds_read_b64_tr_b16 v[26:27], v224 offset:41472
    ds_read_b128 v[164:167], v11 offset:16384
    v_mfma_f32_32x32x16_bf16 v[48:63], v[32:35], v[156:159], v[48:63]
    s_add_u32 m0, s82, 0
    ds_read_b64_tr_b16 v[28:29], v225 offset:40960
    ds_read_b64_tr_b16 v[30:31], v225 offset:41472
    ds_read_b128 v[168:171], v12 offset:16384
    buffer_load_dwordx4 v6, s[40:43], s11 offen offset:0 lds
    v_mfma_f32_32x32x16_bf16 v[64:79], v[36:39], v[156:159], v[64:79]
    ds_read_b64_tr_b16 v[32:33], v224 offset:34816
    ds_read_b64_tr_b16 v[34:35], v224 offset:35328
    ds_read_b128 v[172:175], v13 offset:16384
    v_mfma_f32_32x32x16_bf16 v[80:95], v[40:43], v[156:159], v[80:95]
    ds_read_b64_tr_b16 v[36:37], v225 offset:34816
    ds_read_b64_tr_b16 v[38:39], v225 offset:35328
    buffer_load_dwordx4 v7, s[40:43], s11 offen offset:1024 lds
    v_mfma_f32_32x32x16_bf16 v[96:111], v[44:47], v[156:159], v[96:111]
    ds_read_b64_tr_b16 v[40:41], v224 offset:43008
    ds_read_b64_tr_b16 v[42:43], v224 offset:43520
    s_waitcnt lgkmcnt(13)
    v_mfma_f32_32x32x16_bf16 v[48:63], v[16:19], v[160:163], v[48:63]
    ds_read_b64_tr_b16 v[44:45], v225 offset:43008
    ds_read_b64_tr_b16 v[46:47], v225 offset:43520
    v_mfma_f32_32x32x16_bf16 v[64:79], v[20:23], v[160:163], v[64:79]
    ds_read_b64_tr_b16 v[16:17], v224 offset:36864
    ds_read_b64_tr_b16 v[18:19], v224 offset:37376
    buffer_load_dwordx4 v8, s[40:43], s11 offen offset:2048 lds
    s_waitcnt lgkmcnt(12)
    v_mfma_f32_32x32x16_bf16 v[80:95], v[24:27], v[160:163], v[80:95]
    ds_read_b64_tr_b16 v[20:21], v225 offset:36864
    ds_read_b64_tr_b16 v[22:23], v225 offset:37376
    v_mfma_f32_32x32x16_bf16 v[96:111], v[28:31], v[160:163], v[96:111]
    ds_read_b64_tr_b16 v[24:25], v224 offset:45056
    ds_read_b64_tr_b16 v[26:27], v224 offset:45568
    buffer_load_dwordx4 v9, s[40:43], s11 offen offset:3072 lds
    s_waitcnt lgkmcnt(10)
    v_mfma_f32_32x32x16_bf16 v[48:63], v[32:35], v[164:167], v[48:63]
    ds_read_b64_tr_b16 v[28:29], v225 offset:45056
    ds_read_b64_tr_b16 v[30:31], v225 offset:45568
    v_mfma_f32_32x32x16_bf16 v[64:79], v[36:39], v[164:167], v[64:79]
    ds_read_b64_tr_b16 v[32:33], v224 offset:38912
    ds_read_b64_tr_b16 v[34:35], v224 offset:39424
    s_waitcnt lgkmcnt(10)
    v_mfma_f32_32x32x16_bf16 v[80:95], v[40:43], v[164:167], v[80:95]
    s_add_u32 m0, s82, 16384
    ds_read_b64_tr_b16 v[36:37], v225 offset:38912
    ds_read_b64_tr_b16 v[38:39], v225 offset:39424
    buffer_load_dwordx4 v2, s[44:47], s18 offen offset:0 lds
    v_mfma_f32_32x32x16_bf16 v[96:111], v[44:47], v[164:167], v[96:111]
    ds_read_b64_tr_b16 v[40:41], v224 offset:47104
    ds_read_b64_tr_b16 v[42:43], v224 offset:47616
    buffer_load_dwordx4 v3, s[44:47], s18 offen offset:1024 lds
    s_waitcnt lgkmcnt(10)
    v_mfma_f32_32x32x16_bf16 v[48:63], v[16:19], v[168:171], v[48:63]
    ds_read_b64_tr_b16 v[44:45], v225 offset:47104
    ds_read_b64_tr_b16 v[46:47], v225 offset:47616
    buffer_load_dwordx4 v4, s[44:47], s18 offen offset:2048 lds
    v_mfma_f32_32x32x16_bf16 v[64:79], v[20:23], v[168:171], v[64:79]
    buffer_load_dwordx4 v5, s[44:47], s18 offen offset:3072 lds
    s_waitcnt lgkmcnt(8)
    v_mfma_f32_32x32x16_bf16 v[80:95], v[24:27], v[168:171], v[80:95]
    s_waitcnt lgkmcnt(0)
    s_waitcnt vmcnt(8)
    s_barrier
    ds_read_b128 v[176:179], v10 offset:49152
    ds_read_b64_tr_b16 v[16:17], v226 offset:0
    ds_read_b64_tr_b16 v[18:19], v226 offset:512
    ds_read_b64_tr_b16 v[20:21], v227 offset:0
    ds_read_b64_tr_b16 v[22:23], v227 offset:512
    v_mfma_f32_32x32x16_bf16 v[96:111], v[28:31], v[168:171], v[96:111]
    ds_read_b64_tr_b16 v[24:25], v226 offset:8192
    ds_read_b64_tr_b16 v[26:27], v226 offset:8704
    ds_read_b128 v[180:183], v11 offset:49152
    v_mfma_f32_32x32x16_bf16 v[48:63], v[32:35], v[172:175], v[48:63]
    s_add_u32 m0, s82, 32768
    ds_read_b64_tr_b16 v[28:29], v227 offset:8192
    ds_read_b64_tr_b16 v[30:31], v227 offset:8704
    ds_read_b128 v[184:187], v12 offset:49152
    buffer_load_dwordx4 v6, s[40:43], s12 offen offset:0 lds
    v_mfma_f32_32x32x16_bf16 v[64:79], v[36:39], v[172:175], v[64:79]
    ds_read_b64_tr_b16 v[32:33], v226 offset:2048
    ds_read_b64_tr_b16 v[34:35], v226 offset:2560
    ds_read_b128 v[188:191], v13 offset:49152
    v_mfma_f32_32x32x16_bf16 v[80:95], v[40:43], v[172:175], v[80:95]
    ds_read_b64_tr_b16 v[36:37], v227 offset:2048
    ds_read_b64_tr_b16 v[38:39], v227 offset:2560
    buffer_load_dwordx4 v7, s[40:43], s12 offen offset:1024 lds
    v_mfma_f32_32x32x16_bf16 v[96:111], v[44:47], v[172:175], v[96:111]
    ds_read_b64_tr_b16 v[40:41], v226 offset:10240
    ds_read_b64_tr_b16 v[42:43], v226 offset:10752
    s_waitcnt lgkmcnt(13)
    v_mfma_f32_32x32x16_bf16 v[48:63], v[16:19], v[176:179], v[48:63]
    ds_read_b64_tr_b16 v[44:45], v227 offset:10240
    ds_read_b64_tr_b16 v[46:47], v227 offset:10752
    v_mfma_f32_32x32x16_bf16 v[64:79], v[20:23], v[176:179], v[64:79]
    ds_read_b64_tr_b16 v[16:17], v226 offset:4096
    ds_read_b64_tr_b16 v[18:19], v226 offset:4608
    buffer_load_dwordx4 v8, s[40:43], s12 offen offset:2048 lds
    s_waitcnt lgkmcnt(12)
    v_mfma_f32_32x32x16_bf16 v[80:95], v[24:27], v[176:179], v[80:95]
    ds_read_b64_tr_b16 v[20:21], v227 offset:4096
    ds_read_b64_tr_b16 v[22:23], v227 offset:4608
    v_mfma_f32_32x32x16_bf16 v[96:111], v[28:31], v[176:179], v[96:111]
    ds_read_b64_tr_b16 v[24:25], v226 offset:12288
    ds_read_b64_tr_b16 v[26:27], v226 offset:12800
    buffer_load_dwordx4 v9, s[40:43], s12 offen offset:3072 lds
    s_waitcnt lgkmcnt(10)
    v_mfma_f32_32x32x16_bf16 v[48:63], v[32:35], v[180:183], v[48:63]
    ds_read_b64_tr_b16 v[28:29], v227 offset:12288
    ds_read_b64_tr_b16 v[30:31], v227 offset:12800
    v_mfma_f32_32x32x16_bf16 v[64:79], v[36:39], v[180:183], v[64:79]
    ds_read_b64_tr_b16 v[32:33], v226 offset:6144
    ds_read_b64_tr_b16 v[34:35], v226 offset:6656
    s_waitcnt lgkmcnt(10)
    v_mfma_f32_32x32x16_bf16 v[80:95], v[40:43], v[180:183], v[80:95]
    s_add_u32 m0, s82, 49152
    ds_read_b64_tr_b16 v[36:37], v227 offset:6144
    ds_read_b64_tr_b16 v[38:39], v227 offset:6656
    buffer_load_dwordx4 v2, s[44:47], s19 offen offset:0 lds
    v_mfma_f32_32x32x16_bf16 v[96:111], v[44:47], v[180:183], v[96:111]
    ds_read_b64_tr_b16 v[40:41], v226 offset:14336
    ds_read_b64_tr_b16 v[42:43], v226 offset:14848
    buffer_load_dwordx4 v3, s[44:47], s19 offen offset:1024 lds
    s_waitcnt lgkmcnt(10)
    v_mfma_f32_32x32x16_bf16 v[48:63], v[16:19], v[184:187], v[48:63]
    ds_read_b64_tr_b16 v[44:45], v227 offset:14336
    ds_read_b64_tr_b16 v[46:47], v227 offset:14848
    buffer_load_dwordx4 v4, s[44:47], s19 offen offset:2048 lds
    v_mfma_f32_32x32x16_bf16 v[64:79], v[20:23], v[184:187], v[64:79]
    buffer_load_dwordx4 v5, s[44:47], s19 offen offset:3072 lds
    s_waitcnt lgkmcnt(8)
    v_mfma_f32_32x32x16_bf16 v[80:95], v[24:27], v[184:187], v[80:95]
    s_waitcnt lgkmcnt(0)
    s_waitcnt vmcnt(8)
    s_barrier
    buffer_store_dword v228, v255, s[52:55], 0 offen sc1
    ds_read_b128 v[192:195], v10 offset:0
    ds_read_b64_tr_b16 v[16:17], v224 offset:16384
    ds_read_b64_tr_b16 v[18:19], v224 offset:16896
    ds_read_b64_tr_b16 v[20:21], v225 offset:16384
    ds_read_b64_tr_b16 v[22:23], v225 offset:16896
    v_mfma_f32_32x32x16_bf16 v[96:111], v[28:31], v[184:187], v[96:111]
    ds_read_b64_tr_b16 v[24:25], v224 offset:24576
    ds_read_b64_tr_b16 v[26:27], v224 offset:25088
    ds_read_b128 v[196:199], v11 offset:0
    v_mfma_f32_32x32x16_bf16 v[48:63], v[32:35], v[188:191], v[48:63]
    s_add_u32 m0, s82, 65536
    s_add_u32 s13, s13, 128
    ds_read_b64_tr_b16 v[28:29], v225 offset:24576
    ds_read_b64_tr_b16 v[30:31], v225 offset:25088
    ds_read_b128 v[200:203], v12 offset:0
    buffer_load_dwordx4 v2, s[44:47], s13 offen offset:0 lds
    v_mfma_f32_32x32x16_bf16 v[64:79], v[36:39], v[188:191], v[64:79]
    ds_read_b64_tr_b16 v[32:33], v224 offset:18432
    ds_read_b64_tr_b16 v[34:35], v224 offset:18944
    ds_read_b128 v[204:207], v13 offset:0
    v_mfma_f32_32x32x16_bf16 v[80:95], v[40:43], v[188:191], v[80:95]
    ds_read_b64_tr_b16 v[36:37], v225 offset:18432
    ds_read_b64_tr_b16 v[38:39], v225 offset:18944
    buffer_load_dwordx4 v3, s[44:47], s13 offen offset:1024 lds
    v_mfma_f32_32x32x16_bf16 v[96:111], v[44:47], v[188:191], v[96:111]
    ds_read_b64_tr_b16 v[40:41], v224 offset:26624
    ds_read_b64_tr_b16 v[42:43], v224 offset:27136
    s_waitcnt lgkmcnt(13)
    v_mfma_f32_32x32x16_bf16 v[48:63], v[16:19], v[192:195], v[48:63]
    ds_read_b64_tr_b16 v[44:45], v225 offset:26624
    ds_read_b64_tr_b16 v[46:47], v225 offset:27136
    v_mfma_f32_32x32x16_bf16 v[64:79], v[20:23], v[192:195], v[64:79]
    ds_read_b64_tr_b16 v[16:17], v224 offset:20480
    ds_read_b64_tr_b16 v[18:19], v224 offset:20992
    buffer_load_dwordx4 v4, s[44:47], s13 offen offset:2048 lds
    s_waitcnt lgkmcnt(12)
    v_mfma_f32_32x32x16_bf16 v[80:95], v[24:27], v[192:195], v[80:95]
    ds_read_b64_tr_b16 v[20:21], v225 offset:20480
    ds_read_b64_tr_b16 v[22:23], v225 offset:20992
    v_mfma_f32_32x32x16_bf16 v[96:111], v[28:31], v[192:195], v[96:111]
    ds_read_b64_tr_b16 v[24:25], v224 offset:28672
    ds_read_b64_tr_b16 v[26:27], v224 offset:29184
    buffer_load_dwordx4 v5, s[44:47], s13 offen offset:3072 lds
    s_waitcnt lgkmcnt(10)
    v_mfma_f32_32x32x16_bf16 v[48:63], v[32:35], v[196:199], v[48:63]
    ds_read_b64_tr_b16 v[28:29], v225 offset:28672
    ds_read_b64_tr_b16 v[30:31], v225 offset:29184
    v_mfma_f32_32x32x16_bf16 v[64:79], v[36:39], v[196:199], v[64:79]
    ds_read_b64_tr_b16 v[32:33], v224 offset:22528
    ds_read_b64_tr_b16 v[34:35], v224 offset:23040
    s_waitcnt lgkmcnt(10)
    v_mfma_f32_32x32x16_bf16 v[80:95], v[40:43], v[196:199], v[80:95]
    s_add_u32 m0, s82, 0
    s_add_u32 s14, s14, 128
    ds_read_b64_tr_b16 v[36:37], v225 offset:22528
    ds_read_b64_tr_b16 v[38:39], v225 offset:23040
    buffer_load_dwordx4 v2, s[44:47], s14 offen offset:0 lds
    v_mfma_f32_32x32x16_bf16 v[96:111], v[44:47], v[196:199], v[96:111]
    ds_read_b64_tr_b16 v[40:41], v224 offset:30720
    ds_read_b64_tr_b16 v[42:43], v224 offset:31232
    buffer_load_dwordx4 v3, s[44:47], s14 offen offset:1024 lds
    s_waitcnt lgkmcnt(10)
    v_mfma_f32_32x32x16_bf16 v[48:63], v[16:19], v[200:203], v[48:63]
    ds_read_b64_tr_b16 v[44:45], v225 offset:30720
    ds_read_b64_tr_b16 v[46:47], v225 offset:31232
    buffer_load_dwordx4 v4, s[44:47], s14 offen offset:2048 lds
    v_mfma_f32_32x32x16_bf16 v[64:79], v[20:23], v[200:203], v[64:79]
    buffer_load_dwordx4 v5, s[44:47], s14 offen offset:3072 lds
    s_waitcnt lgkmcnt(8)
    v_mfma_f32_32x32x16_bf16 v[80:95], v[24:27], v[200:203], v[80:95]
    s_waitcnt lgkmcnt(0)
    s_waitcnt vmcnt(9)
    s_barrier
    ds_read_b128 v[208:211], v10 offset:32768
    ds_read_b64_tr_b16 v[16:17], v224 offset:49152
    ds_read_b64_tr_b16 v[18:19], v224 offset:49664
    ds_read_b64_tr_b16 v[20:21], v225 offset:49152
    ds_read_b64_tr_b16 v[22:23], v225 offset:49664
    v_mfma_f32_32x32x16_bf16 v[96:111], v[28:31], v[200:203], v[96:111]
    ds_read_b64_tr_b16 v[24:25], v224 offset:57344
    ds_read_b64_tr_b16 v[26:27], v224 offset:57856
    ds_read_b128 v[212:215], v11 offset:32768
    v_mfma_f32_32x32x16_bf16 v[48:63], v[32:35], v[204:207], v[48:63]
    s_add_u32 m0, s82, 16384
    s_add_u32 s15, s15, 128
    ds_read_b64_tr_b16 v[28:29], v225 offset:57344
    ds_read_b64_tr_b16 v[30:31], v225 offset:57856
    ds_read_b128 v[216:219], v12 offset:32768
    buffer_load_dwordx4 v2, s[44:47], s15 offen offset:0 lds
    v_mfma_f32_32x32x16_bf16 v[64:79], v[36:39], v[204:207], v[64:79]
    ds_read_b64_tr_b16 v[32:33], v224 offset:51200
    ds_read_b64_tr_b16 v[34:35], v224 offset:51712
    ds_read_b128 v[220:223], v13 offset:32768
    v_mfma_f32_32x32x16_bf16 v[80:95], v[40:43], v[204:207], v[80:95]
    ds_read_b64_tr_b16 v[36:37], v225 offset:51200
    ds_read_b64_tr_b16 v[38:39], v225 offset:51712
    buffer_load_dwordx4 v3, s[44:47], s15 offen offset:1024 lds
    v_mfma_f32_32x32x16_bf16 v[96:111], v[44:47], v[204:207], v[96:111]
    ds_read_b64_tr_b16 v[40:41], v224 offset:59392
    ds_read_b64_tr_b16 v[42:43], v224 offset:59904
    s_waitcnt lgkmcnt(13)
    v_mfma_f32_32x32x16_bf16 v[48:63], v[16:19], v[208:211], v[48:63]
    ds_read_b64_tr_b16 v[44:45], v225 offset:59392
    ds_read_b64_tr_b16 v[46:47], v225 offset:59904
    v_mfma_f32_32x32x16_bf16 v[64:79], v[20:23], v[208:211], v[64:79]
    ds_read_b64_tr_b16 v[16:17], v224 offset:53248
    ds_read_b64_tr_b16 v[18:19], v224 offset:53760
    buffer_load_dwordx4 v4, s[44:47], s15 offen offset:2048 lds
    s_waitcnt lgkmcnt(12)
    v_mfma_f32_32x32x16_bf16 v[80:95], v[24:27], v[208:211], v[80:95]
    ds_read_b64_tr_b16 v[20:21], v225 offset:53248
    ds_read_b64_tr_b16 v[22:23], v225 offset:53760
    v_mfma_f32_32x32x16_bf16 v[96:111], v[28:31], v[208:211], v[96:111]
    ds_read_b64_tr_b16 v[24:25], v224 offset:61440
    ds_read_b64_tr_b16 v[26:27], v224 offset:61952
    buffer_load_dwordx4 v5, s[44:47], s15 offen offset:3072 lds
    s_waitcnt lgkmcnt(10)
    v_mfma_f32_32x32x16_bf16 v[48:63], v[32:35], v[212:215], v[48:63]
    ds_read_b64_tr_b16 v[28:29], v225 offset:61440
    ds_read_b64_tr_b16 v[30:31], v225 offset:61952
    v_mfma_f32_32x32x16_bf16 v[64:79], v[36:39], v[212:215], v[64:79]
    ds_read_b64_tr_b16 v[32:33], v224 offset:55296
    ds_read_b64_tr_b16 v[34:35], v224 offset:55808
    s_waitcnt lgkmcnt(10)
    v_mfma_f32_32x32x16_bf16 v[80:95], v[40:43], v[212:215], v[80:95]
    ds_read_b64_tr_b16 v[36:37], v225 offset:55296
    ds_read_b64_tr_b16 v[38:39], v225 offset:55808
    s_add_u32 m0, s82, 32768
    s_nop 0
    buffer_load_dwordx4 v230, s[48:51], s80 offen lds
    v_mfma_f32_32x32x16_bf16 v[96:111], v[44:47], v[212:215], v[96:111]
    buffer_load_dwordx4 v231, s[48:51], s80 offen offset:1024 lds
    ds_read_b64_tr_b16 v[40:41], v224 offset:63488
    ds_read_b64_tr_b16 v[42:43], v224 offset:64000
    s_waitcnt lgkmcnt(10)
    v_mfma_f32_32x32x16_bf16 v[48:63], v[16:19], v[216:219], v[48:63]
    ds_read_b64_tr_b16 v[44:45], v225 offset:63488
    ds_read_b64_tr_b16 v[46:47], v225 offset:64000
    s_add_u32 m0, s82, 34816
    s_add_u32 s80, s80, 114688
    buffer_load_dwordx4 v230, s[48:51], s80 offen lds
    v_mfma_f32_32x32x16_bf16 v[64:79], v[20:23], v[216:219], v[64:79]
    buffer_load_dwordx4 v231, s[48:51], s80 offen offset:1024 lds
    s_waitcnt lgkmcnt(8)
    v_mfma_f32_32x32x16_bf16 v[80:95], v[24:27], v[216:219], v[80:95]
    v_mov_b32 v10, v1
    v_xor_b32 v11, 64, v1
    v_add_u32 v12, 0x10000, v10
    v_add_u32 v13, 0x10000, v11
    v_mfma_f32_32x32x16_bf16 v[96:111], v[28:31], v[216:219], v[96:111]
    s_waitcnt lgkmcnt(4)
    v_mfma_f32_32x32x16_bf16 v[48:63], v[32:35], v[220:223], v[48:63]
    v_mfma_f32_32x32x16_bf16 v[64:79], v[36:39], v[220:223], v[64:79]
    s_waitcnt lgkmcnt(0)
    v_mfma_f32_32x32x16_bf16 v[80:95], v[40:43], v[220:223], v[80:95]
    v_mfma_f32_32x32x16_bf16 v[96:111], v[44:47], v[220:223], v[96:111]
    s_nop 7
    v_pk_mul_f32 v[232:233], v[48:49], s[76:77]
    v_pk_mul_f32 v[234:235], v[50:51], s[76:77]
    v_pk_mul_f32 v[236:237], v[52:53], s[76:77]
    v_pk_mul_f32 v[238:239], v[54:55], s[76:77]
    v_exp_f32 v232, v232
    v_exp_f32 v233, v233
    v_exp_f32 v234, v234
    v_exp_f32 v235, v235
    v_exp_f32 v236, v236
    v_exp_f32 v237, v237
    v_exp_f32 v238, v238
    v_exp_f32_e64 v239, v239
    v_pk_mul_f32 v[240:241], v[48:49], v[80:81]
    v_pk_mul_f32 v[242:243], v[50:51], v[82:83]
    v_pk_mul_f32 v[244:245], v[52:53], v[84:85]
    v_pk_mul_f32 v[246:247], v[54:55], v[86:87]
    v_pk_add_f32 v[232:233], v[232:233], 1.0 op_sel_hi:[1,0]
    v_pk_add_f32 v[234:235], v[234:235], 1.0 op_sel_hi:[1,0]
    v_pk_add_f32 v[236:237], v[236:237], 1.0 op_sel_hi:[1,0]
    v_pk_add_f32 v[238:239], v[238:239], 1.0 op_sel_hi:[1,0]
    v_rcp_f32 v232, v232
    v_rcp_f32 v233, v233
    v_rcp_f32 v234, v234
    v_rcp_f32 v235, v235
    v_rcp_f32 v236, v236
    v_rcp_f32 v237, v237
    v_rcp_f32 v238, v238
    v_rcp_f32 v239, v239
    v_pk_mul_f32 v[240:241], v[240:241], v[232:233]
    v_pk_mul_f32 v[242:243], v[242:243], v[234:235]
    v_pk_mul_f32 v[244:245], v[244:245], v[236:237]
    v_pk_mul_f32 v[246:247], v[246:247], v[238:239]
    v_cvt_pk_bf16_f32 v248, v240, v241
    v_cvt_pk_bf16_f32 v249, v242, v243
    v_cvt_pk_bf16_f32 v250, v244, v245
    v_cvt_pk_bf16_f32 v251, v246, v247
    s_add_u32 s92, s85, 0
    buffer_store_dwordx4 v[248:251], v14, s[52:55], s92 offen offset:0 sc1
    v_pk_mul_f32 v[232:233], v[56:57], s[76:77]
    v_pk_mul_f32 v[234:235], v[58:59], s[76:77]
    v_pk_mul_f32 v[236:237], v[60:61], s[76:77]
    v_pk_mul_f32 v[238:239], v[62:63], s[76:77]
    v_exp_f32 v232, v232
    v_exp_f32 v233, v233
    v_exp_f32 v234, v234
    v_exp_f32 v235, v235
    v_exp_f32 v236, v236
    v_exp_f32 v237, v237
    v_exp_f32 v238, v238
    v_exp_f32_e64 v239, v239
    v_pk_mul_f32 v[240:241], v[56:57], v[88:89]
    v_pk_mul_f32 v[242:243], v[58:59], v[90:91]
    v_pk_mul_f32 v[244:245], v[60:61], v[92:93]
    v_pk_mul_f32 v[246:247], v[62:63], v[94:95]
    v_pk_add_f32 v[232:233], v[232:233], 1.0 op_sel_hi:[1,0]
    v_pk_add_f32 v[234:235], v[234:235], 1.0 op_sel_hi:[1,0]
    v_pk_add_f32 v[236:237], v[236:237], 1.0 op_sel_hi:[1,0]
    v_pk_add_f32 v[238:239], v[238:239], 1.0 op_sel_hi:[1,0]
    v_rcp_f32 v232, v232
    v_rcp_f32 v233, v233
    v_rcp_f32 v234, v234
    v_rcp_f32 v235, v235
    v_rcp_f32 v236, v236
    v_rcp_f32 v237, v237
    v_rcp_f32 v238, v238
    v_rcp_f32 v239, v239
    v_pk_mul_f32 v[240:241], v[240:241], v[232:233]
    v_pk_mul_f32 v[242:243], v[242:243], v[234:235]
    v_pk_mul_f32 v[244:245], v[244:245], v[236:237]
    v_pk_mul_f32 v[246:247], v[246:247], v[238:239]
    v_cvt_pk_bf16_f32 v252, v240, v241
    v_cvt_pk_bf16_f32 v253, v242, v243
    v_cvt_pk_bf16_f32 v254, v244, v245
    v_cvt_pk_bf16_f32 v255, v246, v247
    buffer_store_dwordx4 v[252:255], v14, s[52:55], s92 offen offset:2048 sc1
    v_pk_mul_f32 v[232:233], v[64:65], s[76:77]
    v_pk_mul_f32 v[234:235], v[66:67], s[76:77]
    v_pk_mul_f32 v[236:237], v[68:69], s[76:77]
    v_pk_mul_f32 v[238:239], v[70:71], s[76:77]
    v_exp_f32 v232, v232
    v_exp_f32 v233, v233
    v_exp_f32 v234, v234
    v_exp_f32 v235, v235
    v_exp_f32 v236, v236
    v_exp_f32 v237, v237
    v_exp_f32 v238, v238
    v_exp_f32 v239, v239
    v_pk_mul_f32 v[240:241], v[64:65], v[96:97]
    v_pk_mul_f32 v[242:243], v[66:67], v[98:99]
    v_pk_mul_f32 v[244:245], v[68:69], v[100:101]
    v_pk_mul_f32 v[246:247], v[70:71], v[102:103]
    v_pk_add_f32 v[232:233], v[232:233], 1.0 op_sel_hi:[1,0]
    v_pk_add_f32 v[234:235], v[234:235], 1.0 op_sel_hi:[1,0]
    v_pk_add_f32 v[236:237], v[236:237], 1.0 op_sel_hi:[1,0]
    v_pk_add_f32 v[238:239], v[238:239], 1.0 op_sel_hi:[1,0]
    v_rcp_f32 v232, v232
    v_rcp_f32 v233, v233
    v_rcp_f32 v234, v234
    v_rcp_f32 v235, v235
    v_rcp_f32 v236, v236
    v_rcp_f32 v237, v237
    v_rcp_f32 v238, v238
    v_rcp_f32 v239, v239
    v_pk_mul_f32 v[240:241], v[240:241], v[232:233]
    v_pk_mul_f32 v[242:243], v[242:243], v[234:235]
    v_pk_mul_f32 v[244:245], v[244:245], v[236:237]
    v_pk_mul_f32 v[246:247], v[246:247], v[238:239]
    v_cvt_pk_bf16_f32 v248, v240, v241
    v_cvt_pk_bf16_f32 v249, v242, v243
    v_cvt_pk_bf16_f32 v250, v244, v245
    v_cvt_pk_bf16_f32 v251, v246, v247
    s_add_u32 s92, s85, 4096
    buffer_store_dwordx4 v[248:251], v14, s[52:55], s92 offen offset:0 sc1
    v_pk_mul_f32 v[232:233], v[72:73], s[76:77]
    v_pk_mul_f32 v[234:235], v[74:75], s[76:77]
    v_pk_mul_f32 v[236:237], v[76:77], s[76:77]
    v_pk_mul_f32 v[238:239], v[78:79], s[76:77]
    v_exp_f32 v232, v232
    v_exp_f32 v233, v233
    v_exp_f32 v234, v234
    v_exp_f32 v235, v235
    v_exp_f32 v236, v236
    v_exp_f32 v237, v237
    v_exp_f32 v238, v238
    v_exp_f32 v239, v239
    v_pk_mul_f32 v[240:241], v[72:73], v[104:105]
    v_pk_mul_f32 v[242:243], v[74:75], v[106:107]
    v_pk_mul_f32 v[244:245], v[76:77], v[108:109]
    v_pk_mul_f32 v[246:247], v[78:79], v[110:111]
    v_pk_add_f32 v[232:233], v[232:233], 1.0 op_sel_hi:[1,0]
    v_pk_add_f32 v[234:235], v[234:235], 1.0 op_sel_hi:[1,0]
    v_pk_add_f32 v[236:237], v[236:237], 1.0 op_sel_hi:[1,0]
    v_pk_add_f32 v[238:239], v[238:239], 1.0 op_sel_hi:[1,0]
    s_waitcnt lgkmcnt(0)
    s_waitcnt vmcnt(15)
    s_barrier
    ds_read_b64_tr_b16 v[16:17], v226 offset:0
    ds_read_b64_tr_b16 v[18:19], v226 offset:512
    ds_read_b64_tr_b16 v[20:21], v227 offset:0
    ds_read_b64_tr_b16 v[22:23], v227 offset:512
    ds_read_b64_tr_b16 v[24:25], v226 offset:8192
    ds_read_b64_tr_b16 v[26:27], v226 offset:8704
    ds_read_b64_tr_b16 v[28:29], v227 offset:8192
    ds_read_b64_tr_b16 v[30:31], v227 offset:8704
    ds_read_b64_tr_b16 v[32:33], v226 offset:2048
    ds_read_b64_tr_b16 v[34:35], v226 offset:2560
    ds_read_b64_tr_b16 v[36:37], v227 offset:2048
    ds_read_b64_tr_b16 v[38:39], v227 offset:2560
    ds_read_b64_tr_b16 v[40:41], v226 offset:10240
    ds_read_b64_tr_b16 v[42:43], v226 offset:10752
    v_rcp_f32 v232, v232
    v_rcp_f32 v233, v233
    v_rcp_f32 v234, v234
    v_rcp_f32 v235, v235
    v_rcp_f32 v236, v236
    v_rcp_f32 v237, v237
    v_rcp_f32 v238, v238
    v_rcp_f32_e64 v239, v239
    v_pk_mul_f32 v[240:241], v[240:241], v[232:233]
    v_pk_mul_f32 v[242:243], v[242:243], v[234:235]
    v_pk_mul_f32 v[244:245], v[244:245], v[236:237]
    v_pk_mul_f32 v[246:247], v[246:247], v[238:239]
    v_cvt_pk_bf16_f32 v252, v240, v241
    v_cvt_pk_bf16_f32 v253, v242, v243
    v_cvt_pk_bf16_f32 v254, v244, v245
    v_cvt_pk_bf16_f32 v255, v246, v247
    buffer_store_dwordx4 v[252:255], v14, s[52:55], s92 offen offset:2048 sc1
    s_waitcnt lgkmcnt(10)
    v_mfma_f32_32x32x16_bf16 v[48:63], v[16:19], v[112:115], 0
    ds_read_b64_tr_b16 v[44:45], v227 offset:10240
    ds_read_b64_tr_b16 v[46:47], v227 offset:10752
    v_mfma_f32_32x32x16_bf16 v[64:79], v[20:23], v[112:115], 0
    ds_read_b64_tr_b16 v[16:17], v226 offset:4096
    ds_read_b64_tr_b16 v[18:19], v226 offset:4608
    s_add_u32 m0, s82, 49152
    s_add_u32 s80, s80, 114688
    buffer_load_dwordx4 v230, s[48:51], s80 offen lds
    s_waitcnt lgkmcnt(10)
    v_mfma_f32_32x32x16_bf16 v[80:95], v[24:27], v[112:115], 0
    ds_read_b64_tr_b16 v[20:21], v227 offset:4096
    ds_read_b64_tr_b16 v[22:23], v227 offset:4608
    v_mfma_f32_32x32x16_bf16 v[96:111], v[28:31], v[112:115], 0
    buffer_load_dwordx4 v231, s[48:51], s80 offen offset:1024 lds
    ds_read_b64_tr_b16 v[24:25], v226 offset:12288
    ds_read_b64_tr_b16 v[26:27], v226 offset:12800
    s_waitcnt lgkmcnt(10)
    v_mfma_f32_32x32x16_bf16 v[48:63], v[32:35], v[116:119], v[48:63]
    ds_read_b64_tr_b16 v[28:29], v227 offset:12288
    ds_read_b64_tr_b16 v[30:31], v227 offset:12800
    v_mfma_f32_32x32x16_bf16 v[64:79], v[36:39], v[116:119], v[64:79]
    ds_read_b64_tr_b16 v[32:33], v226 offset:6144
    ds_read_b64_tr_b16 v[34:35], v226 offset:6656
    s_add_u32 m0, s82, 51200
    s_add_u32 s80, s80, 114688
    buffer_load_dwordx4 v230, s[48:51], s80 offen lds
    s_waitcnt lgkmcnt(10)
    v_mfma_f32_32x32x16_bf16 v[80:95], v[40:43], v[116:119], v[80:95]
    ds_read_b64_tr_b16 v[36:37], v227 offset:6144
    ds_read_b64_tr_b16 v[38:39], v227 offset:6656
    v_mfma_f32_32x32x16_bf16 v[96:111], v[44:47], v[116:119], v[96:111]
    buffer_load_dwordx4 v231, s[48:51], s80 offen offset:1024 lds
    ds_read_b64_tr_b16 v[40:41], v226 offset:14336
    ds_read_b64_tr_b16 v[42:43], v226 offset:14848
    s_waitcnt lgkmcnt(10)
    v_mfma_f32_32x32x16_bf16 v[48:63], v[16:19], v[120:123], v[48:63]
    ds_read_b64_tr_b16 v[44:45], v227 offset:14336
    ds_read_b64_tr_b16 v[46:47], v227 offset:14848
    v_mfma_f32_32x32x16_bf16 v[64:79], v[20:23], v[120:123], v[64:79]
    s_waitcnt lgkmcnt(8)
    v_mfma_f32_32x32x16_bf16 v[80:95], v[24:27], v[120:123], v[80:95]
    s_waitcnt lgkmcnt(0)
    s_waitcnt vmcnt(16)
    s_barrier
    ds_read_b64_tr_b16 v[16:17], v224 offset:0
    ds_read_b64_tr_b16 v[18:19], v224 offset:512
    ds_read_b64_tr_b16 v[20:21], v225 offset:0
    ds_read_b64_tr_b16 v[22:23], v225 offset:512
    v_mfma_f32_32x32x16_bf16 v[96:111], v[28:31], v[120:123], v[96:111]
    s_add_u32 m0, s82, 65536
    s_add_u32 s16, s16, 128
    ds_read_b64_tr_b16 v[24:25], v224 offset:8192
    ds_read_b64_tr_b16 v[26:27], v224 offset:8704
    buffer_load_dwordx4 v2, s[44:47], s16 offen offset:0 lds
    v_mfma_f32_32x32x16_bf16 v[48:63], v[32:35], v[124:127], v[48:63]
    ds_read_b64_tr_b16 v[28:29], v225 offset:8192
    ds_read_b64_tr_b16 v[30:31], v225 offset:8704
    v_mfma_f32_32x32x16_bf16 v[64:79], v[36:39], v[124:127], v[64:79]
    ds_read_b64_tr_b16 v[32:33], v224 offset:2048
    ds_read_b64_tr_b16 v[34:35], v224 offset:2560
    buffer_load_dwordx4 v3, s[44:47], s16 offen offset:1024 lds
    v_mfma_f32_32x32x16_bf16 v[80:95], v[40:43], v[124:127], v[80:95]
    ds_read_b64_tr_b16 v[36:37], v225 offset:2048
    ds_read_b64_tr_b16 v[38:39], v225 offset:2560
    v_mfma_f32_32x32x16_bf16 v[96:111], v[44:47], v[124:127], v[96:111]
    ds_read_b64_tr_b16 v[40:41], v224 offset:10240
    ds_read_b64_tr_b16 v[42:43], v224 offset:10752
    buffer_load_dwordx4 v4, s[44:47], s16 offen offset:2048 lds
    s_waitcnt lgkmcnt(10)
    v_mfma_f32_32x32x16_bf16 v[48:63], v[16:19], v[128:131], v[48:63]
    ds_read_b64_tr_b16 v[44:45], v225 offset:10240
    ds_read_b64_tr_b16 v[46:47], v225 offset:10752
    v_mfma_f32_32x32x16_bf16 v[64:79], v[20:23], v[128:131], v[64:79]
    ds_read_b64_tr_b16 v[16:17], v224 offset:4096
    ds_read_b64_tr_b16 v[18:19], v224 offset:4608
    buffer_load_dwordx4 v5, s[44:47], s16 offen offset:3072 lds
    s_waitcnt lgkmcnt(10)
    v_mfma_f32_32x32x16_bf16 v[80:95], v[24:27], v[128:131], v[80:95]
    ds_read_b64_tr_b16 v[20:21], v225 offset:4096
    ds_read_b64_tr_b16 v[22:23], v225 offset:4608
    v_mfma_f32_32x32x16_bf16 v[96:111], v[28:31], v[128:131], v[96:111]
    ds_read_b64_tr_b16 v[24:25], v224 offset:12288
    ds_read_b64_tr_b16 v[26:27], v224 offset:12800
    s_waitcnt lgkmcnt(10)
    v_mfma_f32_32x32x16_bf16 v[48:63], v[32:35], v[132:135], v[48:63]
    ds_read_b64_tr_b16 v[28:29], v225 offset:12288
    ds_read_b64_tr_b16 v[30:31], v225 offset:12800
    v_mfma_f32_32x32x16_bf16 v[64:79], v[36:39], v[132:135], v[64:79]
    ds_read_b64_tr_b16 v[32:33], v224 offset:6144
    ds_read_b64_tr_b16 v[34:35], v224 offset:6656
    s_waitcnt lgkmcnt(10)
    v_mfma_f32_32x32x16_bf16 v[80:95], v[40:43], v[132:135], v[80:95]
    ds_read_b64_tr_b16 v[36:37], v225 offset:6144
    ds_read_b64_tr_b16 v[38:39], v225 offset:6656
    v_mfma_f32_32x32x16_bf16 v[96:111], v[44:47], v[132:135], v[96:111]
    ds_read_b64_tr_b16 v[40:41], v224 offset:14336
    ds_read_b64_tr_b16 v[42:43], v224 offset:14848
    s_waitcnt lgkmcnt(10)
    v_mfma_f32_32x32x16_bf16 v[48:63], v[16:19], v[136:139], v[48:63]
    ds_read_b64_tr_b16 v[44:45], v225 offset:14336
    ds_read_b64_tr_b16 v[46:47], v225 offset:14848
    v_mfma_f32_32x32x16_bf16 v[64:79], v[20:23], v[136:139], v[64:79]
    s_waitcnt lgkmcnt(8)
    v_mfma_f32_32x32x16_bf16 v[80:95], v[24:27], v[136:139], v[80:95]
    s_waitcnt lgkmcnt(0)
    s_waitcnt vmcnt(8)
    s_barrier
    buffer_store_dword v228, v15, s[52:55], 0 offen sc1
    ds_read_b64_tr_b16 v[16:17], v224 offset:16384
    ds_read_b64_tr_b16 v[18:19], v224 offset:16896
    ds_read_b64_tr_b16 v[20:21], v225 offset:16384
    ds_read_b64_tr_b16 v[22:23], v225 offset:16896
    v_mfma_f32_32x32x16_bf16 v[96:111], v[28:31], v[136:139], v[96:111]
    s_add_u32 m0, s82, 0
    s_add_u32 s17, s17, 128
    ds_read_b64_tr_b16 v[24:25], v224 offset:24576
    ds_read_b64_tr_b16 v[26:27], v224 offset:25088
    buffer_load_dwordx4 v2, s[44:47], s17 offen offset:0 lds
    v_mfma_f32_32x32x16_bf16 v[48:63], v[32:35], v[140:143], v[48:63]
    ds_read_b64_tr_b16 v[28:29], v225 offset:24576
    ds_read_b64_tr_b16 v[30:31], v225 offset:25088
    ds_read_b64_tr_b16 v[112:113], v10 offset:32768
    ds_read_b64_tr_b16 v[114:115], v10 offset:33280
    ds_read_b64_tr_b16 v[116:117], v11 offset:32768
    ds_read_b64_tr_b16 v[118:119], v11 offset:33280
    v_mfma_f32_32x32x16_bf16 v[64:79], v[36:39], v[140:143], v[64:79]
    ds_read_b64_tr_b16 v[32:33], v224 offset:18432
    ds_read_b64_tr_b16 v[34:35], v224 offset:18944
    buffer_load_dwordx4 v3, s[44:47], s17 offen offset:1024 lds
    v_mfma_f32_32x32x16_bf16 v[80:95], v[40:43], v[140:143], v[80:95]
    ds_read_b64_tr_b16 v[36:37], v225 offset:18432
    ds_read_b64_tr_b16 v[38:39], v225 offset:18944
    v_mfma_f32_32x32x16_bf16 v[96:111], v[44:47], v[140:143], v[96:111]
    ds_read_b64_tr_b16 v[40:41], v224 offset:26624
    ds_read_b64_tr_b16 v[42:43], v224 offset:27136
    buffer_load_dwordx4 v4, s[44:47], s17 offen offset:2048 lds
    s_waitcnt lgkmcnt(14)
    v_mfma_f32_32x32x16_bf16 v[48:63], v[16:19], v[144:147], v[48:63]
    ds_read_b64_tr_b16 v[44:45], v225 offset:26624
    ds_read_b64_tr_b16 v[46:47], v225 offset:27136
    v_mfma_f32_32x32x16_bf16 v[64:79], v[20:23], v[144:147], v[64:79]
    ds_read_b64_tr_b16 v[16:17], v224 offset:20480
    ds_read_b64_tr_b16 v[18:19], v224 offset:20992
    buffer_load_dwordx4 v5, s[44:47], s17 offen offset:3072 lds
    s_waitcnt lgkmcnt(14)
    v_mfma_f32_32x32x16_bf16 v[80:95], v[24:27], v[144:147], v[80:95]
    ds_read_b64_tr_b16 v[20:21], v225 offset:20480
    ds_read_b64_tr_b16 v[22:23], v225 offset:20992
    v_mfma_f32_32x32x16_bf16 v[96:111], v[28:31], v[144:147], v[96:111]
    ds_read_b64_tr_b16 v[24:25], v224 offset:28672
    ds_read_b64_tr_b16 v[26:27], v224 offset:29184
    s_waitcnt lgkmcnt(10)
    v_mfma_f32_32x32x16_bf16 v[48:63], v[32:35], v[148:151], v[48:63]
    ds_read_b64_tr_b16 v[28:29], v225 offset:28672
    ds_read_b64_tr_b16 v[30:31], v225 offset:29184
    v_mfma_f32_32x32x16_bf16 v[64:79], v[36:39], v[148:151], v[64:79]
    ds_read_b64_tr_b16 v[32:33], v224 offset:22528
    ds_read_b64_tr_b16 v[34:35], v224 offset:23040
    s_waitcnt lgkmcnt(10)
    v_mfma_f32_32x32x16_bf16 v[80:95], v[40:43], v[148:151], v[80:95]
    ds_read_b64_tr_b16 v[36:37], v225 offset:22528
    ds_read_b64_tr_b16 v[38:39], v225 offset:23040
    v_mfma_f32_32x32x16_bf16 v[96:111], v[44:47], v[148:151], v[96:111]
    ds_read_b64_tr_b16 v[40:41], v224 offset:30720
    ds_read_b64_tr_b16 v[42:43], v224 offset:31232
    s_waitcnt lgkmcnt(10)
    v_mfma_f32_32x32x16_bf16 v[48:63], v[16:19], v[152:155], v[48:63]
    ds_read_b64_tr_b16 v[44:45], v225 offset:30720
    ds_read_b64_tr_b16 v[46:47], v225 offset:31232
    v_mfma_f32_32x32x16_bf16 v[64:79], v[20:23], v[152:155], v[64:79]
    ds_read_b64_tr_b16 v[120:121], v10 offset:34816
    ds_read_b64_tr_b16 v[122:123], v10 offset:35328
    ds_read_b64_tr_b16 v[124:125], v11 offset:34816
    ds_read_b64_tr_b16 v[126:127], v11 offset:35328
    s_waitcnt lgkmcnt(12)
    v_mfma_f32_32x32x16_bf16 v[80:95], v[24:27], v[152:155], v[80:95]
    s_waitcnt lgkmcnt(0)
    s_waitcnt vmcnt(5)
    s_barrier
    ds_read_b64_tr_b16 v[16:17], v226 offset:0
    ds_read_b64_tr_b16 v[18:19], v226 offset:512
    ds_read_b64_tr_b16 v[20:21], v227 offset:0
    ds_read_b64_tr_b16 v[22:23], v227 offset:512
    v_mfma_f32_32x32x16_bf16 v[96:111], v[28:31], v[152:155], v[96:111]
    s_add_u32 m0, s82, 16384
    s_add_u32 s18, s18, 128
    ds_read_b64_tr_b16 v[24:25], v226 offset:8192
    ds_read_b64_tr_b16 v[26:27], v226 offset:8704
    buffer_load_dwordx4 v2, s[44:47], s18 offen offset:0 lds
    v_mfma_f32_32x32x16_bf16 v[48:63], v[32:35], v[156:159], v[48:63]
    ds_read_b64_tr_b16 v[28:29], v227 offset:8192
    ds_read_b64_tr_b16 v[30:31], v227 offset:8704
    ds_read_b64_tr_b16 v[128:129], v10 offset:49152
    ds_read_b64_tr_b16 v[130:131], v10 offset:49664
    ds_read_b64_tr_b16 v[132:133], v11 offset:49152
    ds_read_b64_tr_b16 v[134:135], v11 offset:49664
    v_mfma_f32_32x32x16_bf16 v[64:79], v[36:39], v[156:159], v[64:79]
    ds_read_b64_tr_b16 v[32:33], v226 offset:2048
    ds_read_b64_tr_b16 v[34:35], v226 offset:2560
    buffer_load_dwordx4 v3, s[44:47], s18 offen offset:1024 lds
    v_mfma_f32_32x32x16_bf16 v[80:95], v[40:43], v[156:159], v[80:95]
    ds_read_b64_tr_b16 v[36:37], v227 offset:2048
    ds_read_b64_tr_b16 v[38:39], v227 offset:2560
    v_mfma_f32_32x32x16_bf16 v[96:111], v[44:47], v[156:159], v[96:111]
    ds_read_b64_tr_b16 v[40:41], v226 offset:10240
    ds_read_b64_tr_b16 v[42:43], v226 offset:10752
    buffer_load_dwordx4 v4, s[44:47], s18 offen offset:2048 lds
    s_waitcnt lgkmcnt(14)
    v_mfma_f32_32x32x16_bf16 v[48:63], v[16:19], v[160:163], v[48:63]
    ds_read_b64_tr_b16 v[44:45], v227 offset:10240
    ds_read_b64_tr_b16 v[46:47], v227 offset:10752
    v_mfma_f32_32x32x16_bf16 v[64:79], v[20:23], v[160:163], v[64:79]
    ds_read_b64_tr_b16 v[16:17], v226 offset:4096
    ds_read_b64_tr_b16 v[18:19], v226 offset:4608
    buffer_load_dwordx4 v5, s[44:47], s18 offen offset:3072 lds
    s_waitcnt lgkmcnt(14)
    v_mfma_f32_32x32x16_bf16 v[80:95], v[24:27], v[160:163], v[80:95]
    ds_read_b64_tr_b16 v[20:21], v227 offset:4096
    ds_read_b64_tr_b16 v[22:23], v227 offset:4608
    v_mfma_f32_32x32x16_bf16 v[96:111], v[28:31], v[160:163], v[96:111]
    ds_read_b64_tr_b16 v[24:25], v226 offset:12288
    ds_read_b64_tr_b16 v[26:27], v226 offset:12800
    s_add_u32 m0, s82, 32768
    s_add_u32 s80, s80, 114688
    buffer_load_dwordx4 v230, s[48:51], s80 offen lds
    s_waitcnt lgkmcnt(10)
    v_mfma_f32_32x32x16_bf16 v[48:63], v[32:35], v[164:167], v[48:63]
    ds_read_b64_tr_b16 v[28:29], v227 offset:12288
    ds_read_b64_tr_b16 v[30:31], v227 offset:12800
    v_mfma_f32_32x32x16_bf16 v[64:79], v[36:39], v[164:167], v[64:79]
    buffer_load_dwordx4 v231, s[48:51], s80 offen offset:1024 lds
    ds_read_b64_tr_b16 v[32:33], v226 offset:6144
    ds_read_b64_tr_b16 v[34:35], v226 offset:6656
    s_waitcnt lgkmcnt(10)
    v_mfma_f32_32x32x16_bf16 v[80:95], v[40:43], v[164:167], v[80:95]
    ds_read_b64_tr_b16 v[36:37], v227 offset:6144
    ds_read_b64_tr_b16 v[38:39], v227 offset:6656
    v_mfma_f32_32x32x16_bf16 v[96:111], v[44:47], v[164:167], v[96:111]
    ds_read_b64_tr_b16 v[40:41], v226 offset:14336
    ds_read_b64_tr_b16 v[42:43], v226 offset:14848
    s_add_u32 m0, s82, 34816
    s_add_u32 s80, s80, 114688
    buffer_load_dwordx4 v230, s[48:51], s80 offen lds
    s_waitcnt lgkmcnt(10)
    v_mfma_f32_32x32x16_bf16 v[48:63], v[16:19], v[168:171], v[48:63]
    ds_read_b64_tr_b16 v[44:45], v227 offset:14336
    ds_read_b64_tr_b16 v[46:47], v227 offset:14848
    v_mfma_f32_32x32x16_bf16 v[64:79], v[20:23], v[168:171], v[64:79]
    buffer_load_dwordx4 v231, s[48:51], s80 offen offset:1024 lds
    ds_read_b64_tr_b16 v[136:137], v10 offset:51200
    ds_read_b64_tr_b16 v[138:139], v10 offset:51712
    ds_read_b64_tr_b16 v[140:141], v11 offset:51200
    ds_read_b64_tr_b16 v[142:143], v11 offset:51712
    s_waitcnt lgkmcnt(12)
    v_mfma_f32_32x32x16_bf16 v[80:95], v[24:27], v[168:171], v[80:95]
    s_waitcnt lgkmcnt(0)
    s_waitcnt vmcnt(8)
    s_barrier
    ds_read_b64_tr_b16 v[16:17], v224 offset:0
    ds_read_b64_tr_b16 v[18:19], v224 offset:512
    ds_read_b64_tr_b16 v[20:21], v225 offset:0
    ds_read_b64_tr_b16 v[22:23], v225 offset:512
    v_mfma_f32_32x32x16_bf16 v[96:111], v[28:31], v[168:171], v[96:111]
    s_add_u32 m0, s82, 65536
    s_add_u32 s19, s19, 128
    ds_read_b64_tr_b16 v[24:25], v224 offset:8192
    ds_read_b64_tr_b16 v[26:27], v224 offset:8704
    buffer_load_dwordx4 v2, s[44:47], s19 offen offset:0 lds
    v_mfma_f32_32x32x16_bf16 v[48:63], v[32:35], v[172:175], v[48:63]
    ds_read_b64_tr_b16 v[28:29], v225 offset:8192
    ds_read_b64_tr_b16 v[30:31], v225 offset:8704
    v_mfma_f32_32x32x16_bf16 v[64:79], v[36:39], v[172:175], v[64:79]
    ds_read_b64_tr_b16 v[32:33], v224 offset:2048
    ds_read_b64_tr_b16 v[34:35], v224 offset:2560
    buffer_load_dwordx4 v3, s[44:47], s19 offen offset:1024 lds
    v_mfma_f32_32x32x16_bf16 v[80:95], v[40:43], v[172:175], v[80:95]
    ds_read_b64_tr_b16 v[36:37], v225 offset:2048
    ds_read_b64_tr_b16 v[38:39], v225 offset:2560
    v_mfma_f32_32x32x16_bf16 v[96:111], v[44:47], v[172:175], v[96:111]
    ds_read_b64_tr_b16 v[40:41], v224 offset:10240
    ds_read_b64_tr_b16 v[42:43], v224 offset:10752
    buffer_load_dwordx4 v4, s[44:47], s19 offen offset:2048 lds
    s_waitcnt lgkmcnt(10)
    v_mfma_f32_32x32x16_bf16 v[48:63], v[16:19], v[176:179], v[48:63]
    ds_read_b64_tr_b16 v[44:45], v225 offset:10240
    ds_read_b64_tr_b16 v[46:47], v225 offset:10752
    v_mfma_f32_32x32x16_bf16 v[64:79], v[20:23], v[176:179], v[64:79]
    ds_read_b64_tr_b16 v[16:17], v224 offset:4096
    ds_read_b64_tr_b16 v[18:19], v224 offset:4608
    buffer_load_dwordx4 v5, s[44:47], s19 offen offset:3072 lds
    s_waitcnt lgkmcnt(10)
    v_mfma_f32_32x32x16_bf16 v[80:95], v[24:27], v[176:179], v[80:95]
    ds_read_b64_tr_b16 v[20:21], v225 offset:4096
    ds_read_b64_tr_b16 v[22:23], v225 offset:4608
    v_mfma_f32_32x32x16_bf16 v[96:111], v[28:31], v[176:179], v[96:111]
    ds_read_b64_tr_b16 v[24:25], v224 offset:12288
    ds_read_b64_tr_b16 v[26:27], v224 offset:12800
    s_add_u32 m0, s82, 49152
    s_add_u32 s80, s80, 114688
    buffer_load_dwordx4 v230, s[48:51], s80 offen lds
    s_waitcnt lgkmcnt(10)
    v_mfma_f32_32x32x16_bf16 v[48:63], v[32:35], v[180:183], v[48:63]
    ds_read_b64_tr_b16 v[28:29], v225 offset:12288
    ds_read_b64_tr_b16 v[30:31], v225 offset:12800
    v_mfma_f32_32x32x16_bf16 v[64:79], v[36:39], v[180:183], v[64:79]
    buffer_load_dwordx4 v231, s[48:51], s80 offen offset:1024 lds
    ds_read_b64_tr_b16 v[32:33], v224 offset:6144
    ds_read_b64_tr_b16 v[34:35], v224 offset:6656
    s_waitcnt lgkmcnt(10)
    v_mfma_f32_32x32x16_bf16 v[80:95], v[40:43], v[180:183], v[80:95]
    ds_read_b64_tr_b16 v[36:37], v225 offset:6144
    ds_read_b64_tr_b16 v[38:39], v225 offset:6656
    v_mfma_f32_32x32x16_bf16 v[96:111], v[44:47], v[180:183], v[96:111]
    ds_read_b64_tr_b16 v[40:41], v224 offset:14336
    ds_read_b64_tr_b16 v[42:43], v224 offset:14848
    s_add_u32 m0, s82, 51200
    s_add_u32 s80, s80, 114688
    buffer_load_dwordx4 v230, s[48:51], s80 offen lds
    s_waitcnt lgkmcnt(10)
    v_mfma_f32_32x32x16_bf16 v[48:63], v[16:19], v[184:187], v[48:63]
    ds_read_b64_tr_b16 v[44:45], v225 offset:14336
    ds_read_b64_tr_b16 v[46:47], v225 offset:14848
    v_mfma_f32_32x32x16_bf16 v[64:79], v[20:23], v[184:187], v[64:79]
    buffer_load_dwordx4 v231, s[48:51], s80 offen offset:1024 lds
    s_waitcnt vmcnt(10)
    ds_read_b64_tr_b16 v[144:145], v10 offset:32768
    ds_read_b64_tr_b16 v[146:147], v10 offset:33280
    ds_read_b64_tr_b16 v[148:149], v11 offset:32768
    ds_read_b64_tr_b16 v[150:151], v11 offset:33280
    s_waitcnt lgkmcnt(12)
    v_mfma_f32_32x32x16_bf16 v[80:95], v[24:27], v[184:187], v[80:95]
    s_waitcnt lgkmcnt(0)
    s_barrier
    ds_read_b64_tr_b16 v[16:17], v224 offset:16384
    ds_read_b64_tr_b16 v[18:19], v224 offset:16896
    ds_read_b64_tr_b16 v[20:21], v225 offset:16384
    ds_read_b64_tr_b16 v[22:23], v225 offset:16896
    v_mfma_f32_32x32x16_bf16 v[96:111], v[28:31], v[184:187], v[96:111]
    ds_read_b64_tr_b16 v[24:25], v224 offset:24576
    ds_read_b64_tr_b16 v[26:27], v224 offset:25088
    s_add_u32 m0, s82, 0
    s_add_u32 s80, s80, 114688
    buffer_load_dwordx4 v230, s[48:51], s80 offen lds
    v_mfma_f32_32x32x16_bf16 v[48:63], v[32:35], v[188:191], v[48:63]
    ds_read_b64_tr_b16 v[28:29], v225 offset:24576
    ds_read_b64_tr_b16 v[30:31], v225 offset:25088
    s_waitcnt vmcnt(9)
    ds_read_b64_tr_b16 v[152:153], v10 offset:34816
    ds_read_b64_tr_b16 v[154:155], v10 offset:35328
    ds_read_b64_tr_b16 v[156:157], v11 offset:34816
    ds_read_b64_tr_b16 v[158:159], v11 offset:35328
    v_mfma_f32_32x32x16_bf16 v[64:79], v[36:39], v[188:191], v[64:79]
    buffer_load_dwordx4 v231, s[48:51], s80 offen offset:1024 lds
    ds_read_b64_tr_b16 v[32:33], v224 offset:18432
    ds_read_b64_tr_b16 v[34:35], v224 offset:18944
    v_mfma_f32_32x32x16_bf16 v[80:95], v[40:43], v[188:191], v[80:95]
    ds_read_b64_tr_b16 v[36:37], v225 offset:18432
    ds_read_b64_tr_b16 v[38:39], v225 offset:18944
    v_writelane_b32 v15, 2.0, 16
    s_add_u32 s78, s87, 131072
    v_min_u32 v232, 13, v0
    v_lshlrev_b32 v232, 2, v232
    s_lshr_b32 s72, s60, 1
    s_lshl_b32 s72, s72, 10
    v_or_b32_e64 v2, s72, v14
    v_xor_b32 v3, 0x400, v2
    v_mfma_f32_32x32x16_bf16 v[96:111], v[44:47], v[188:191], v[96:111]
    ds_read_b64_tr_b16 v[40:41], v224 offset:26624
    ds_read_b64_tr_b16 v[42:43], v224 offset:27136
    s_add_u32 m0, s82, 2048
    s_add_u32 s80, s80, 114688
    buffer_load_dwordx4 v230, s[48:51], s80 offen lds
    s_waitcnt lgkmcnt(14)
    v_mfma_f32_32x32x16_bf16 v[48:63], v[16:19], v[192:195], v[48:63]
    ds_read_b64_tr_b16 v[44:45], v225 offset:26624
    ds_read_b64_tr_b16 v[46:47], v225 offset:27136
    v_mfma_f32_32x32x16_bf16 v[64:79], v[20:23], v[192:195], v[64:79]
    buffer_load_dwordx4 v231, s[48:51], s80 offen offset:1024 lds
    ds_read_b64_tr_b16 v[16:17], v224 offset:20480
    ds_read_b64_tr_b16 v[18:19], v224 offset:20992
    s_waitcnt lgkmcnt(14)
    v_mfma_f32_32x32x16_bf16 v[80:95], v[24:27], v[192:195], v[80:95]
    ds_read_b64_tr_b16 v[20:21], v225 offset:20480
    ds_read_b64_tr_b16 v[22:23], v225 offset:20992
    v_mfma_f32_32x32x16_bf16 v[96:111], v[28:31], v[192:195], v[96:111]
    ds_read_b64_tr_b16 v[24:25], v224 offset:28672
    ds_read_b64_tr_b16 v[26:27], v224 offset:29184
    s_add_u32 m0, s82, 32768
    s_add_u32 s80, s80, 114688
    buffer_load_dwordx4 v230, s[48:51], s80 offen lds
    s_waitcnt lgkmcnt(10)
    v_mfma_f32_32x32x16_bf16 v[48:63], v[32:35], v[196:199], v[48:63]
    ds_read_b64_tr_b16 v[28:29], v225 offset:28672
    ds_read_b64_tr_b16 v[30:31], v225 offset:29184
    v_mfma_f32_32x32x16_bf16 v[64:79], v[36:39], v[196:199], v[64:79]
    buffer_load_dwordx4 v231, s[48:51], s80 offen offset:1024 lds
    ds_read_b64_tr_b16 v[32:33], v224 offset:22528
    ds_read_b64_tr_b16 v[34:35], v224 offset:23040
    s_waitcnt lgkmcnt(10)
    v_mfma_f32_32x32x16_bf16 v[80:95], v[40:43], v[196:199], v[80:95]
    ds_read_b64_tr_b16 v[36:37], v225 offset:22528
    ds_read_b64_tr_b16 v[38:39], v225 offset:23040
    v_mfma_f32_32x32x16_bf16 v[96:111], v[44:47], v[196:199], v[96:111]
    ds_read_b64_tr_b16 v[40:41], v224 offset:30720
    ds_read_b64_tr_b16 v[42:43], v224 offset:31232
    s_waitcnt lgkmcnt(10)
    v_mfma_f32_32x32x16_bf16 v[48:63], v[16:19], v[200:203], v[48:63]
    ds_read_b64_tr_b16 v[44:45], v225 offset:30720
    ds_read_b64_tr_b16 v[46:47], v225 offset:31232
    v_mfma_f32_32x32x16_bf16 v[64:79], v[20:23], v[200:203], v[64:79]
    s_waitcnt vmcnt(8)
    ds_read_b64_tr_b16 v[160:161], v10 offset:49152
    ds_read_b64_tr_b16 v[162:163], v10 offset:49664
    ds_read_b64_tr_b16 v[164:165], v11 offset:49152
    ds_read_b64_tr_b16 v[166:167], v11 offset:49664
    s_waitcnt lgkmcnt(12)
    v_mfma_f32_32x32x16_bf16 v[80:95], v[24:27], v[200:203], v[80:95]
    s_waitcnt lgkmcnt(0)
    s_barrier
    ds_read_b64_tr_b16 v[16:17], v226 offset:0
    ds_read_b64_tr_b16 v[18:19], v226 offset:512
    ds_read_b64_tr_b16 v[20:21], v227 offset:0
    ds_read_b64_tr_b16 v[22:23], v227 offset:512
    v_mfma_f32_32x32x16_bf16 v[96:111], v[28:31], v[200:203], v[96:111]
    ds_read_b64_tr_b16 v[24:25], v226 offset:8192
    ds_read_b64_tr_b16 v[26:27], v226 offset:8704
    s_add_u32 m0, s82, 16384
    s_add_u32 s80, s80, 114688
    buffer_load_dwordx4 v230, s[48:51], s80 offen lds
    v_mfma_f32_32x32x16_bf16 v[48:63], v[32:35], v[204:207], v[48:63]
    ds_read_b64_tr_b16 v[28:29], v227 offset:8192
    ds_read_b64_tr_b16 v[30:31], v227 offset:8704
    s_waitcnt vmcnt(7)
    ds_read_b64_tr_b16 v[168:169], v10 offset:51200
    ds_read_b64_tr_b16 v[170:171], v10 offset:51712
    ds_read_b64_tr_b16 v[172:173], v11 offset:51200
    ds_read_b64_tr_b16 v[174:175], v11 offset:51712
    v_mfma_f32_32x32x16_bf16 v[64:79], v[36:39], v[204:207], v[64:79]
    buffer_load_dwordx4 v231, s[48:51], s80 offen offset:1024 lds
    ds_read_b64_tr_b16 v[32:33], v226 offset:2048
    ds_read_b64_tr_b16 v[34:35], v226 offset:2560
    v_mfma_f32_32x32x16_bf16 v[80:95], v[40:43], v[204:207], v[80:95]
    ds_read_b64_tr_b16 v[36:37], v227 offset:2048
    ds_read_b64_tr_b16 v[38:39], v227 offset:2560
    v_mfma_f32_32x32x16_bf16 v[96:111], v[44:47], v[204:207], v[96:111]
    ds_read_b64_tr_b16 v[40:41], v226 offset:10240
    ds_read_b64_tr_b16 v[42:43], v226 offset:10752
    s_add_u32 m0, s82, 18432
    s_add_u32 s80, s80, 114688
    buffer_load_dwordx4 v230, s[48:51], s80 offen lds
    buffer_load_dword v233, v232, s[52:55], s78 offen sc1
    s_waitcnt lgkmcnt(14)
    v_mfma_f32_32x32x16_bf16 v[48:63], v[16:19], v[208:211], v[48:63]
    ds_read_b64_tr_b16 v[44:45], v227 offset:10240
    ds_read_b64_tr_b16 v[46:47], v227 offset:10752
    v_mfma_f32_32x32x16_bf16 v[64:79], v[20:23], v[208:211], v[64:79]
    buffer_load_dwordx4 v231, s[48:51], s80 offen offset:1024 lds
    ds_read_b64_tr_b16 v[16:17], v226 offset:4096
    ds_read_b64_tr_b16 v[18:19], v226 offset:4608
    s_waitcnt lgkmcnt(14)
    v_mfma_f32_32x32x16_bf16 v[80:95], v[24:27], v[208:211], v[80:95]
    ds_read_b64_tr_b16 v[20:21], v227 offset:4096
    ds_read_b64_tr_b16 v[22:23], v227 offset:4608
    v_mfma_f32_32x32x16_bf16 v[96:111], v[28:31], v[208:211], v[96:111]
    ds_read_b64_tr_b16 v[24:25], v226 offset:12288
    ds_read_b64_tr_b16 v[26:27], v226 offset:12800
    s_add_u32 m0, s82, 34816
    s_add_u32 s80, s80, 114688
    buffer_load_dwordx4 v230, s[48:51], s80 offen lds
    s_waitcnt lgkmcnt(10)
    v_mfma_f32_32x32x16_bf16 v[48:63], v[32:35], v[212:215], v[48:63]
    ds_read_b64_tr_b16 v[28:29], v227 offset:12288
    ds_read_b64_tr_b16 v[30:31], v227 offset:12800
    v_mfma_f32_32x32x16_bf16 v[64:79], v[36:39], v[212:215], v[64:79]
    buffer_load_dwordx4 v231, s[48:51], s80 offen offset:1024 lds
    ds_read_b64_tr_b16 v[32:33], v226 offset:6144
    ds_read_b64_tr_b16 v[34:35], v226 offset:6656
    s_waitcnt lgkmcnt(10)
    v_mfma_f32_32x32x16_bf16 v[80:95], v[40:43], v[212:215], v[80:95]
    ds_read_b64_tr_b16 v[36:37], v227 offset:6144
    ds_read_b64_tr_b16 v[38:39], v227 offset:6656
    v_mfma_f32_32x32x16_bf16 v[96:111], v[44:47], v[212:215], v[96:111]
    ds_read_b64_tr_b16 v[40:41], v226 offset:14336
    ds_read_b64_tr_b16 v[42:43], v226 offset:14848
    s_add_u32 m0, s82, 49152
    s_mov_b32 s80, s96
    buffer_load_dwordx4 v230, s[48:51], s80 offen lds
    s_waitcnt lgkmcnt(10)
    v_mfma_f32_32x32x16_bf16 v[48:63], v[16:19], v[216:219], v[48:63]
    ds_read_b64_tr_b16 v[44:45], v227 offset:14336
    ds_read_b64_tr_b16 v[46:47], v227 offset:14848
    v_mfma_f32_32x32x16_bf16 v[64:79], v[20:23], v[216:219], v[64:79]
    buffer_load_dwordx4 v231, s[48:51], s80 offen offset:1024 lds
    s_waitcnt lgkmcnt(8)
    v_mfma_f32_32x32x16_bf16 v[80:95], v[24:27], v[216:219], v[80:95]
    s_waitcnt lgkmcnt(0)
    s_waitcnt vmcnt(5)
    v_cmp_ne_u32 vcc, s63, v233
    s_nop 4
    s_cbranch_vccz L_fa1
    s_load_dwordx16 s[4:19], s[36:37], s78 glc
    s_mov_b32 s86, 0
L_pt2:
    s_waitcnt lgkmcnt(0)
    s_cmp_eq_u64 s[4:5], s[88:89]
    s_cbranch_scc0 L_pb3
    s_cmp_eq_u64 s[6:7], s[88:89]
    s_cbranch_scc0 L_pb3
    s_cmp_eq_u64 s[8:9], s[88:89]
    s_cbranch_scc0 L_pb3
    s_cmp_eq_u64 s[10:11], s[88:89]
    s_cbranch_scc0 L_pb3
    s_cmp_eq_u64 s[12:13], s[88:89]
    s_cbranch_scc0 L_pb3
    s_cmp_eq_u64 s[14:15], s[88:89]
    s_cbranch_scc0 L_pb3
    s_cmp_eq_u64 s[16:17], s[88:89]
    s_cbranch_scc0 L_pb3
    s_branch L_po4
L_pb3:
    s_add_u32 s86, s86, 1
    s_cmp_ge_u32 s86, 20000
    s_cbranch_scc1 L_po4
    s_sleep 2
    s_load_dwordx16 s[4:19], s[36:37], s78 glc
    s_branch L_pt2
L_po4:
L_fa1:
    s_barrier
    v_mfma_f32_32x32x16_bf16 v[96:111], v[28:31], v[216:219], v[96:111]
    buffer_load_dwordx4 v[176:179], v2, s[68:71], s81 offen sc1
    v_mfma_f32_32x32x16_bf16 v[48:63], v[32:35], v[220:223], v[48:63]
    v_mfma_f32_32x32x16_bf16 v[64:79], v[36:39], v[220:223], v[64:79]
    buffer_load_dwordx4 v[180:183], v3, s[68:71], s81 offen sc1
    v_mfma_f32_32x32x16_bf16 v[80:95], v[40:43], v[220:223], v[80:95]
    v_mfma_f32_32x32x16_bf16 v[96:111], v[44:47], v[220:223], v[96:111]
    s_add_u32 s81, s81, 16384
    buffer_load_dwordx4 v[184:187], v2, s[68:71], s81 offen sc1
    s_nop 5
    v_mul_f32 v232, s76, v48
    v_mul_f32 v233, s76, v49
    v_mul_f32 v234, s76, v50
    v_mul_f32 v235, s76, v51
    v_mul_f32 v236, s76, v52
    v_mul_f32 v237, s76, v53
    v_mul_f32 v238, s76, v54
    v_mul_f32 v239, s76, v55
    buffer_load_dwordx4 v[188:191], v3, s[68:71], s81 offen sc1
    v_exp_f32 v232, v232
    v_exp_f32 v233, v233
    v_exp_f32 v234, v234
    v_exp_f32 v235, v235
    s_waitcnt lgkmcnt(0)
    v_exp_f32 v236, v236
    v_exp_f32 v237, v237
    v_exp_f32 v238, v238
    v_exp_f32 v239, v239
    s_add_u32 s81, s81, 16384
    buffer_load_dwordx4 v[192:195], v2, s[68:71], s81 offen sc1
    v_mul_f32 v240, v48, v80
    v_mul_f32 v241, v49, v81
    v_mul_f32 v242, v50, v82
    v_mul_f32 v243, v51, v83
    v_mul_f32 v244, v52, v84
    v_mul_f32 v245, v53, v85
    v_mul_f32 v246, v54, v86
    v_mul_f32 v247, v55, v87
    v_add_f32 v232, 1.0, v232
    v_add_f32 v233, 1.0, v233
    v_add_f32 v234, 1.0, v234
    v_add_f32 v235, 1.0, v235
    v_add_f32 v236, 1.0, v236
    v_add_f32 v237, 1.0, v237
    v_add_f32 v238, 1.0, v238
    v_add_f32 v239, 1.0, v239
    buffer_load_dwordx4 v[196:199], v3, s[68:71], s81 offen sc1
    v_rcp_f32 v232, v232
    v_rcp_f32 v233, v233
    v_rcp_f32 v234, v234
    v_rcp_f32 v235, v235
    s_add_u32 s81, s81, 16384
    buffer_load_dwordx4 v[200:203], v2, s[68:71], s81 offen sc1
    v_rcp_f32 v236, v236
    v_rcp_f32 v237, v237
    v_rcp_f32 v238, v238
    v_rcp_f32 v239, v239
    buffer_load_dwordx4 v[204:207], v3, s[68:71], s81 offen sc1
    v_mul_f32 v240, v240, v232
    v_mul_f32 v241, v241, v233
    v_mul_f32 v242, v242, v234
    v_mul_f32 v243, v243, v235
    v_mul_f32 v244, v244, v236
    v_mul_f32 v245, v245, v237
    v_mul_f32 v246, v246, v238
    v_mul_f32 v247, v247, v239
    v_cvt_pk_bf16_f32 v248, v240, v241
    v_cvt_pk_bf16_f32 v249, v242, v243
    v_cvt_pk_bf16_f32 v250, v244, v245
    v_cvt_pk_bf16_f32 v251, v246, v247
    s_add_u32 s92, s85, 8192
    buffer_store_dwordx4 v[248:251], v14, s[52:55], s92 offen offset:0 sc1
    s_add_u32 s81, s81, 16384
    buffer_load_dwordx4 v[208:211], v2, s[68:71], s81 offen sc1
    v_mul_f32 v232, s76, v56
    v_mul_f32 v233, s76, v57
    v_mul_f32 v234, s76, v58
    v_mul_f32 v235, s76, v59
    v_mul_f32 v236, s76, v60
    v_mul_f32 v237, s76, v61
    v_mul_f32 v238, s76, v62
    v_mul_f32 v239, s76, v63
    buffer_load_dwordx4 v[212:215], v3, s[68:71], s81 offen sc1
    v_exp_f32 v232, v232
    v_exp_f32 v233, v233
    v_exp_f32 v234, v234
    v_exp_f32 v235, v235
    s_add_u32 s81, s81, 16384
    buffer_load_dwordx4 v[216:219], v2, s[68:71], s81 offen sc1
    v_exp_f32 v236, v236
    v_exp_f32 v237, v237
    v_exp_f32 v238, v238
    v_exp_f32 v239, v239
    buffer_load_dwordx4 v[220:223], v3, s[68:71], s81 offen sc1
    v_mul_f32 v240, v56, v88
    v_mul_f32 v241, v57, v89
    v_mul_f32 v242, v58, v90
    v_mul_f32 v243, v59, v91
    v_mul_f32 v244, v60, v92
    v_mul_f32 v245, v61, v93
    v_mul_f32 v246, v62, v94
    v_mul_f32 v247, v63, v95
    v_add_f32 v232, 1.0, v232
    v_add_f32 v233, 1.0, v233
    v_add_f32 v234, 1.0, v234
    v_add_f32 v235, 1.0, v235
    v_add_f32 v236, 1.0, v236
    v_add_f32 v237, 1.0, v237
    v_add_f32 v238, 1.0, v238
    v_add_f32 v239, 1.0, v239
    s_add_u32 s81, s81, 16384
    buffer_load_dwordx4 v[16:19], v2, s[68:71], s81 offen sc1
    v_rcp_f32 v232, v232
    v_rcp_f32 v233, v233
    v_rcp_f32 v234, v234
    v_rcp_f32 v235, v235
    buffer_load_dwordx4 v[20:23], v3, s[68:71], s81 offen sc1
    v_rcp_f32 v236, v236
    v_rcp_f32 v237, v237
    v_rcp_f32 v238, v238
    v_rcp_f32 v239, v239
    s_add_u32 s81, s81, 16384
    buffer_load_dwordx4 v[24:27], v2, s[68:71], s81 offen sc1
    v_mul_f32 v240, v240, v232
    v_mul_f32 v241, v241, v233
    v_mul_f32 v242, v242, v234
    v_mul_f32 v243, v243, v235
    v_mul_f32 v244, v244, v236
    v_mul_f32 v245, v245, v237
    v_mul_f32 v246, v246, v238
    v_mul_f32 v247, v247, v239
    v_cvt_pk_bf16_f32 v252, v240, v241
    v_cvt_pk_bf16_f32 v253, v242, v243
    v_cvt_pk_bf16_f32 v254, v244, v245
    v_cvt_pk_bf16_f32 v255, v246, v247
    buffer_store_dwordx4 v[252:255], v14, s[52:55], s92 offen offset:2048 sc1
    buffer_load_dwordx4 v[28:31], v3, s[68:71], s81 offen sc1
    v_mul_f32 v232, s76, v64
    v_mul_f32 v233, s76, v65
    v_mul_f32 v234, s76, v66
    v_mul_f32 v235, s76, v67
    v_mul_f32 v236, s76, v68
    v_mul_f32 v237, s76, v69
    v_mul_f32 v238, s76, v70
    v_mul_f32 v239, s76, v71
    s_add_u32 s81, s81, 16384
    buffer_load_dwordx4 v[32:35], v2, s[68:71], s81 offen sc1
    v_exp_f32 v232, v232
    v_exp_f32 v233, v233
    v_exp_f32 v234, v234
    v_exp_f32 v235, v235
    buffer_load_dwordx4 v[36:39], v3, s[68:71], s81 offen sc1
    v_exp_f32 v236, v236
    v_exp_f32 v237, v237
    v_exp_f32 v238, v238
    v_exp_f32 v239, v239
    s_add_u32 s81, s81, 16384
    buffer_load_dwordx4 v[40:43], v2, s[68:71], s81 offen sc1
    v_mul_f32 v240, v64, v96
    v_mul_f32 v241, v65, v97
    v_mul_f32 v242, v66, v98
    v_mul_f32 v243, v67, v99
    v_mul_f32 v244, v68, v100
    v_mul_f32 v245, v69, v101
    v_mul_f32 v246, v70, v102
    v_mul_f32 v247, v71, v103
    v_add_f32 v232, 1.0, v232
    v_add_f32 v233, 1.0, v233
    v_add_f32 v234, 1.0, v234
    v_add_f32 v235, 1.0, v235
    v_add_f32 v236, 1.0, v236
    v_add_f32 v237, 1.0, v237
    v_add_f32 v238, 1.0, v238
    v_add_f32 v239, 1.0, v239
    buffer_load_dwordx4 v[44:47], v3, s[68:71], s81 offen sc1
    v_rcp_f32 v232, v232
    v_rcp_f32 v233, v233
    v_rcp_f32 v234, v234
    v_rcp_f32 v235, v235
    s_add_u32 m0, s82, 65536
    s_add_u32 s80, s80, 229376
    buffer_load_dwordx4 v230, s[48:51], s80 offen lds
    v_rcp_f32 v236, v236
    v_rcp_f32 v237, v237
    v_rcp_f32 v238, v238
    v_rcp_f32 v239, v239
    buffer_load_dwordx4 v231, s[48:51], s80 offen offset:1024 lds
    v_mul_f32 v240, v240, v232
    v_mul_f32 v241, v241, v233
    v_mul_f32 v242, v242, v234
    v_mul_f32 v243, v243, v235
    v_mul_f32 v244, v244, v236
    v_mul_f32 v245, v245, v237
    v_mul_f32 v246, v246, v238
    v_mul_f32 v247, v247, v239
    v_cvt_pk_bf16_f32 v248, v240, v241
    v_cvt_pk_bf16_f32 v249, v242, v243
    v_cvt_pk_bf16_f32 v250, v244, v245
    v_cvt_pk_bf16_f32 v251, v246, v247
    s_add_u32 s92, s85, 12288
    buffer_store_dwordx4 v[248:251], v14, s[52:55], s92 offen offset:0 sc1
    s_add_u32 m0, s82, 67584
    s_add_u32 s80, s80, 229376
    buffer_load_dwordx4 v230, s[48:51], s80 offen lds
    v_mul_f32 v232, s76, v72
    v_mul_f32 v233, s76, v73
    v_mul_f32 v234, s76, v74
    v_mul_f32 v235, s76, v75
    v_mul_f32 v236, s76, v76
    v_mul_f32 v237, s76, v77
    v_mul_f32 v238, s76, v78
    v_mul_f32 v239, s76, v79
    buffer_load_dwordx4 v231, s[48:51], s80 offen offset:1024 lds
    v_exp_f32 v232, v232
    v_exp_f32 v233, v233
    v_exp_f32 v234, v234
    v_exp_f32 v235, v235
    v_exp_f32 v236, v236
    v_exp_f32 v237, v237
    v_exp_f32 v238, v238
    v_exp_f32 v239, v239
    s_waitcnt vmcnt(10)
    s_barrier
    buffer_store_dword v228, v15, s[52:55], s39 offen sc1
    s_mov_b32 s39, 0x10000
    v_mul_f32 v240, v72, v104
    v_mul_f32 v241, v73, v105
    v_mul_f32 v242, v74, v106
    v_mul_f32 v243, v75, v107
    v_mul_f32 v244, v76, v108
    v_mul_f32 v245, v77, v109
    v_mul_f32 v246, v78, v110
    v_mul_f32 v247, v79, v111
    v_add_f32 v232, 1.0, v232
    v_add_f32 v233, 1.0, v233
    v_add_f32 v234, 1.0, v234
    v_add_f32 v235, 1.0, v235
    v_add_f32 v236, 1.0, v236
    v_add_f32 v237, 1.0, v237
    v_add_f32 v238, 1.0, v238
    v_add_f32 v239, 1.0, v239
    v_rcp_f32 v232, v232
    v_rcp_f32 v233, v233
    v_rcp_f32 v234, v234
    v_rcp_f32 v235, v235
    v_rcp_f32 v236, v236
    v_rcp_f32 v237, v237
    v_rcp_f32 v238, v238
    v_rcp_f32 v239, v239
    v_mul_f32 v240, v240, v232
    v_mul_f32 v241, v241, v233
    v_mul_f32 v242, v242, v234
    v_mul_f32 v243, v243, v235
    v_mul_f32 v244, v244, v236
    v_mul_f32 v245, v245, v237
    v_mul_f32 v246, v246, v238
    v_mul_f32 v247, v247, v239
    v_cvt_pk_bf16_f32 v252, v240, v241
    v_cvt_pk_bf16_f32 v253, v242, v243
    v_cvt_pk_bf16_f32 v254, v244, v245
    v_cvt_pk_bf16_f32 v255, v246, v247
    buffer_store_dwordx4 v[252:255], v14, s[52:55], s92 offen offset:2048 sc1
    v_mfma_f32_32x32x16_bf16 v[48:63], v[112:115], v[176:179], 0
    s_add_u32 m0, s82, 51200
    s_add_u32 s80, s80, 229376
    buffer_load_dwordx4 v230, s[48:51], s80 offen lds
    v_mfma_f32_32x32x16_bf16 v[80:95], v[112:115], v[180:183], 0
    v_mfma_f32_32x32x16_bf16 v[64:79], v[116:119], v[176:179], 0
    buffer_load_dwordx4 v231, s[48:51], s80 offen offset:1024 lds
    v_mfma_f32_32x32x16_bf16 v[96:111], v[116:119], v[180:183], 0
    v_mfma_f32_32x32x16_bf16 v[48:63], v[120:123], v[184:187], v[48:63]
    s_add_u32 s81, s81, 16384
    buffer_load_dwordx4 v[176:179], v2, s[68:71], s81 offen sc1
    v_mfma_f32_32x32x16_bf16 v[80:95], v[120:123], v[188:191], v[80:95]
    buffer_load_dwordx4 v[180:183], v3, s[68:71], s81 offen sc1
    v_mfma_f32_32x32x16_bf16 v[64:79], v[124:127], v[184:187], v[64:79]
    s_add_u32 s81, s81, 16384
    buffer_load_dwordx4 v[112:115], v2, s[68:71], s81 offen sc1
    v_mfma_f32_32x32x16_bf16 v[96:111], v[124:127], v[188:191], v[96:111]
    s_waitcnt vmcnt(5)
    s_barrier
    buffer_store_dword v228, v15, s[52:55], s39 offen sc1
    v_mfma_f32_32x32x16_bf16 v[48:63], v[128:131], v[192:195], v[48:63]
    buffer_load_dwordx4 v[116:119], v3, s[68:71], s81 offen sc1
    v_mfma_f32_32x32x16_bf16 v[80:95], v[128:131], v[196:199], v[80:95]
    v_mfma_f32_32x32x16_bf16 v[64:79], v[132:135], v[192:195], v[64:79]
    s_add_u32 s81, s81, 16384
    buffer_load_dwordx4 v[248:251], v2, s[68:71], s81 offen sc1
    v_mfma_f32_32x32x16_bf16 v[96:111], v[132:135], v[196:199], v[96:111]
    ds_read_b64_tr_b16 v[184:185], v10 offset:0
    ds_read_b64_tr_b16 v[186:187], v10 offset:512
    ds_read_b64_tr_b16 v[188:189], v11 offset:0
    ds_read_b64_tr_b16 v[190:191], v11 offset:512
    v_mfma_f32_32x32x16_bf16 v[48:63], v[136:139], v[200:203], v[48:63]
    buffer_load_dwordx4 v[252:255], v3, s[68:71], s81 offen sc1
    v_mfma_f32_32x32x16_bf16 v[80:95], v[136:139], v[204:207], v[80:95]
    s_add_u32 s81, s81, 16384
    buffer_load_dwordx4 v[120:123], v2, s[68:71], s81 offen sc1
    v_mfma_f32_32x32x16_bf16 v[64:79], v[140:143], v[200:203], v[64:79]
    buffer_load_dwordx4 v[124:127], v3, s[68:71], s81 offen sc1
    v_mfma_f32_32x32x16_bf16 v[96:111], v[140:143], v[204:207], v[96:111]
    ds_read_b64_tr_b16 v[192:193], v10 offset:2048
    ds_read_b64_tr_b16 v[194:195], v10 offset:2560
    ds_read_b64_tr_b16 v[196:197], v11 offset:2048
    ds_read_b64_tr_b16 v[198:199], v11 offset:2560
    s_waitcnt lgkmcnt(4)
    v_mfma_f32_32x32x16_bf16 v[48:63], v[144:147], v[208:211], v[48:63]
    s_add_u32 m0, s82, 0
    s_add_u32 s80, s80, 229376
    buffer_load_dwordx4 v230, s[48:51], s80 offen lds
    v_mfma_f32_32x32x16_bf16 v[80:95], v[144:147], v[212:215], v[80:95]
    v_mfma_f32_32x32x16_bf16 v[64:79], v[148:151], v[208:211], v[64:79]
    buffer_load_dwordx4 v231, s[48:51], s80 offen offset:1024 lds
    v_mfma_f32_32x32x16_bf16 v[96:111], v[148:151], v[212:215], v[96:111]
    ds_read_b64_tr_b16 v[128:129], v10 offset:32768
    ds_read_b64_tr_b16 v[130:131], v10 offset:33280
    ds_read_b64_tr_b16 v[132:133], v11 offset:32768
    ds_read_b64_tr_b16 v[134:135], v11 offset:33280
    s_waitcnt lgkmcnt(4)
    v_mfma_f32_32x32x16_bf16 v[48:63], v[152:155], v[216:219], v[48:63]
    s_add_u32 m0, s82, 2048
    s_add_u32 s80, s80, 229376
    buffer_load_dwordx4 v230, s[48:51], s80 offen lds
    v_mfma_f32_32x32x16_bf16 v[80:95], v[152:155], v[220:223], v[80:95]
    buffer_load_dwordx4 v231, s[48:51], s80 offen offset:1024 lds
    v_mfma_f32_32x32x16_bf16 v[64:79], v[156:159], v[216:219], v[64:79]
    v_mfma_f32_32x32x16_bf16 v[96:111], v[156:159], v[220:223], v[96:111]
    s_add_u32 s78, s87, 163840
    v_min_u32 v8, 13, v0
    v_lshlrev_b32_e64 v8, 2, v8
    buffer_load_dword v9, v8, s[52:55], s78 offen sc1
    ds_read_b64_tr_b16 v[200:201], v10 offset:16384
    ds_read_b64_tr_b16 v[202:203], v10 offset:16896
    ds_read_b64_tr_b16 v[204:205], v11 offset:16384
    ds_read_b64_tr_b16 v[206:207], v11 offset:16896
    s_waitcnt lgkmcnt(4)
    v_mfma_f32_32x32x16_bf16 v[48:63], v[160:163], v[16:19], v[48:63]
    s_add_u32 m0, s82, 32768
    s_add_u32 s80, s80, 229376
    buffer_load_dwordx4 v230, s[48:51], s80 offen lds
    v_mfma_f32_32x32x16_bf16 v[80:95], v[160:163], v[20:23], v[80:95]
    v_mfma_f32_32x32x16_bf16 v[64:79], v[164:167], v[16:19], v[64:79]
    buffer_load_dwordx4 v231, s[48:51], s80 offen offset:1024 lds
    v_mfma_f32_32x32x16_bf16 v[96:111], v[164:167], v[20:23], v[96:111]
    ds_read_b64_tr_b16 v[136:137], v10 offset:18432
    ds_read_b64_tr_b16 v[138:139], v10 offset:18944
    ds_read_b64_tr_b16 v[140:141], v11 offset:18432
    ds_read_b64_tr_b16 v[142:143], v11 offset:18944
    s_waitcnt lgkmcnt(4)
    v_mfma_f32_32x32x16_bf16 v[48:63], v[168:171], v[24:27], v[48:63]
    s_add_u32 m0, s82, 16384
    s_add_u32 s80, s80, 4293619712
    buffer_load_dwordx4 v230, s[48:51], s80 offen lds
    v_mfma_f32_32x32x16_bf16 v[80:95], v[168:171], v[28:31], v[80:95]
    buffer_load_dwordx4 v231, s[48:51], s80 offen offset:1024 lds
    v_mfma_f32_32x32x16_bf16 v[64:79], v[172:175], v[24:27], v[64:79]
    v_mfma_f32_32x32x16_bf16 v[96:111], v[172:175], v[28:31], v[96:111]
    ds_read_b64_tr_b16 v[208:209], v10 offset:34816
    ds_read_b64_tr_b16 v[210:211], v10 offset:35328
    ds_read_b64_tr_b16 v[212:213], v11 offset:34816
    ds_read_b64_tr_b16 v[214:215], v11 offset:35328
    s_waitcnt lgkmcnt(4)
    v_mfma_f32_32x32x16_bf16 v[48:63], v[184:187], v[32:35], v[48:63]
    s_add_u32 m0, s82, 18432
    s_add_u32 s80, s80, 229376
    buffer_load_dwordx4 v230, s[48:51], s80 offen lds
    v_mfma_f32_32x32x16_bf16 v[80:95], v[184:187], v[36:39], v[80:95]
    v_mfma_f32_32x32x16_bf16 v[64:79], v[188:191], v[32:35], v[64:79]
    buffer_load_dwordx4 v231, s[48:51], s80 offen offset:1024 lds
    v_mfma_f32_32x32x16_bf16 v[96:111], v[188:191], v[36:39], v[96:111]
    s_waitcnt vmcnt(6)
    v_cmp_ne_u32 vcc, s63, v9
    s_nop 4
    s_cbranch_vccz L_fy5
    s_waitcnt lgkmcnt(0)
    s_load_dwordx16 s[4:19], s[36:37], s78 glc
    s_mov_b32 s86, 0
L_pt6:
    s_waitcnt lgkmcnt(0)
    s_cmp_eq_u64 s[4:5], s[88:89]
    s_cbranch_scc0 L_pb7
    s_cmp_eq_u64 s[6:7], s[88:89]
    s_cbranch_scc0 L_pb7
    s_cmp_eq_u64 s[8:9], s[88:89]
    s_cbranch_scc0 L_pb7
    s_cmp_eq_u64 s[10:11], s[88:89]
    s_cbranch_scc0 L_pb7
    s_cmp_eq_u64 s[12:13], s[88:89]
    s_cbranch_scc0 L_pb7
    s_cmp_eq_u64 s[14:15], s[88:89]
    s_cbranch_scc0 L_pb7
    s_cmp_eq_u64 s[16:17], s[88:89]
    s_cbranch_scc0 L_pb7
    s_branch L_po8
L_pb7:
    s_add_u32 s86, s86, 1
    s_cmp_ge_u32 s86, 20000
    s_cbranch_scc1 L_po8
    s_sleep 1
    s_load_dwordx16 s[4:19], s[36:37], s78 glc
    s_branch L_pt6
L_po8:
L_fy5:
    s_mov_b32 s81, s95
    buffer_load_dwordx4 v[144:147], v2, s[68:71], s81 offen sc1
    buffer_load_dwordx4 v[148:151], v3, s[68:71], s81 offen sc1
    ds_read_b64_tr_b16 v[216:217], v10 offset:49152
    ds_read_b64_tr_b16 v[218:219], v10 offset:49664
    ds_read_b64_tr_b16 v[220:221], v11 offset:49152
    ds_read_b64_tr_b16 v[222:223], v11 offset:49664
    s_waitcnt lgkmcnt(4)
    v_mfma_f32_32x32x16_bf16 v[48:63], v[192:195], v[40:43], v[48:63]
    s_add_u32 s81, s81, 32768
    buffer_load_dwordx4 v[152:155], v2, s[68:71], s81 offen sc1
    v_mfma_f32_32x32x16_bf16 v[80:95], v[192:195], v[44:47], v[80:95]
    buffer_load_dwordx4 v[156:159], v3, s[68:71], s81 offen sc1
    v_mfma_f32_32x32x16_bf16 v[64:79], v[196:199], v[40:43], v[64:79]
    s_add_u32 s81, s81, 32768
    buffer_load_dwordx4 v[16:19], v2, s[68:71], s81 offen sc1
    v_mfma_f32_32x32x16_bf16 v[96:111], v[196:199], v[44:47], v[96:111]
    ds_read_b64_tr_b16 v[160:161], v12 offset:0
    ds_read_b64_tr_b16 v[162:163], v12 offset:512
    ds_read_b64_tr_b16 v[164:165], v13 offset:0
    ds_read_b64_tr_b16 v[166:167], v13 offset:512
    s_waitcnt lgkmcnt(4)
    v_mfma_f32_32x32x16_bf16 v[48:63], v[128:131], v[176:179], v[48:63]
    buffer_load_dwordx4 v[20:23], v3, s[68:71], s81 offen sc1
    v_mfma_f32_32x32x16_bf16 v[80:95], v[128:131], v[180:183], v[80:95]
    s_add_u32 s81, s81, 32768
    buffer_load_dwordx4 v[24:27], v2, s[68:71], s81 offen sc1
    v_mfma_f32_32x32x16_bf16 v[64:79], v[132:135], v[176:179], v[64:79]
    buffer_load_dwordx4 v[28:31], v3, s[68:71], s81 offen sc1
    v_mfma_f32_32x32x16_bf16 v[96:111], v[132:135], v[180:183], v[96:111]
    ds_read_b64_tr_b16 v[168:169], v12 offset:2048
    ds_read_b64_tr_b16 v[170:171], v12 offset:2560
    ds_read_b64_tr_b16 v[172:173], v13 offset:2048
    ds_read_b64_tr_b16 v[174:175], v13 offset:2560
    s_waitcnt lgkmcnt(4)
    v_mfma_f32_32x32x16_bf16 v[48:63], v[200:203], v[112:115], v[48:63]
    s_add_u32 s81, s81, 32768
    buffer_load_dwordx4 v[32:35], v2, s[68:71], s81 offen sc1
    v_mfma_f32_32x32x16_bf16 v[80:95], v[200:203], v[116:119], v[80:95]
    buffer_load_dwordx4 v[36:39], v3, s[68:71], s81 offen sc1
    v_mfma_f32_32x32x16_bf16 v[64:79], v[204:207], v[112:115], v[64:79]
    s_add_u32 s81, s81, 32768
    buffer_load_dwordx4 v[184:187], v2, s[68:71], s81 offen sc1
    v_mfma_f32_32x32x16_bf16 v[96:111], v[204:207], v[116:119], v[96:111]
    ds_read_b64_tr_b16 v[40:41], v10 offset:51200
    ds_read_b64_tr_b16 v[42:43], v10 offset:51712
    ds_read_b64_tr_b16 v[44:45], v11 offset:51200
    ds_read_b64_tr_b16 v[46:47], v11 offset:51712
    s_waitcnt lgkmcnt(4)
    v_mfma_f32_32x32x16_bf16 v[48:63], v[136:139], v[248:251], v[48:63]
    buffer_load_dwordx4 v[188:191], v3, s[68:71], s81 offen sc1
    v_mfma_f32_32x32x16_bf16 v[80:95], v[136:139], v[252:255], v[80:95]
    s_add_u32 s81, s81, 32768
    buffer_load_dwordx4 v[192:195], v2, s[68:71], s81 offen sc1
    v_mfma_f32_32x32x16_bf16 v[64:79], v[140:143], v[248:251], v[64:79]
    buffer_load_dwordx4 v[196:199], v3, s[68:71], s81 offen sc1
    v_mfma_f32_32x32x16_bf16 v[96:111], v[140:143], v[252:255], v[96:111]
    s_add_u32 s78, s87, 196608
    v_min_u32 v8, 13, v0
    v_lshlrev_b32 v8, 2, v8
    buffer_load_dword v9, v8, s[52:55], s78 offen sc1
    s_waitcnt lgkmcnt(0)
    v_mfma_f32_32x32x16_bf16 v[48:63], v[208:211], v[120:123], v[48:63]
    s_add_u32 m0, s82, 34816
    s_add_u32 s80, s80, 229376
    buffer_load_dwordx4 v230, s[48:51], s80 offen lds
    v_mfma_f32_32x32x16_bf16 v[80:95], v[208:211], v[124:127], v[80:95]
    buffer_load_dwordx4 v231, s[48:51], s80 offen offset:1024 lds
    v_mfma_f32_32x32x16_bf16 v[64:79], v[212:215], v[120:123], v[64:79]
    s_add_u32 m0, s82, 49152
    s_add_u32 s80, s80, 229376
    buffer_load_dwordx4 v230, s[48:51], s80 offen lds
    v_mfma_f32_32x32x16_bf16 v[96:111], v[212:215], v[124:127], v[96:111]
    s_waitcnt vmcnt(16)
    v_mfma_f32_32x32x16_bf16 v[48:63], v[216:219], v[144:147], v[48:63]
    buffer_load_dwordx4 v231, s[48:51], s80 offen offset:1024 lds
    v_mfma_f32_32x32x16_bf16 v[80:95], v[216:219], v[148:151], v[80:95]
    s_add_u32 m0, s82, 65536
    s_add_u32 s80, s80, 229376
    buffer_load_dwordx4 v230, s[48:51], s80 offen lds
    v_mfma_f32_32x32x16_bf16 v[64:79], v[220:223], v[144:147], v[64:79]
    buffer_load_dwordx4 v231, s[48:51], s80 offen offset:1024 lds
    v_mfma_f32_32x32x16_bf16 v[96:111], v[220:223], v[148:151], v[96:111]
    s_waitcnt vmcnt(17)
    v_mfma_f32_32x32x16_bf16 v[48:63], v[160:163], v[152:155], v[48:63]
    s_add_u32 m0, s82, 67584
    s_add_u32 s80, s80, 229376
    buffer_load_dwordx4 v230, s[48:51], s80 offen lds
    v_mfma_f32_32x32x16_bf16 v[80:95], v[160:163], v[156:159], v[80:95]
    buffer_load_dwordx4 v231, s[48:51], s80 offen offset:1024 lds
    v_mfma_f32_32x32x16_bf16 v[64:79], v[164:167], v[152:155], v[64:79]
    s_add_u32 m0, s82, 51200
    s_add_u32 s80, s80, 229376
    buffer_load_dwordx4 v230, s[48:51], s80 offen lds
    v_mfma_f32_32x32x16_bf16 v[96:111], v[164:167], v[156:159], v[96:111]
    s_waitcnt vmcnt(9)
    v_cmp_ne_u32 vcc, s63, v9
    s_nop 4
    s_cbranch_vccz L_fy9
    s_waitcnt lgkmcnt(0)
    s_load_dwordx16 s[4:19], s[36:37], s78 glc
    s_mov_b32 s86, 0
L_pt10:
    s_waitcnt lgkmcnt(0)
    s_cmp_eq_u64 s[4:5], s[88:89]
    s_cbranch_scc0 L_pb11
    s_cmp_eq_u64 s[6:7], s[88:89]
    s_cbranch_scc0 L_pb11
    s_cmp_eq_u64 s[8:9], s[88:89]
    s_cbranch_scc0 L_pb11
    s_cmp_eq_u64 s[10:11], s[88:89]
    s_cbranch_scc0 L_pb11
    s_cmp_eq_u64 s[12:13], s[88:89]
    s_cbranch_scc0 L_pb11
    s_cmp_eq_u64 s[14:15], s[88:89]
    s_cbranch_scc0 L_pb11
    s_cmp_eq_u64 s[16:17], s[88:89]
    s_cbranch_scc0 L_pb11
    s_branch L_po12
L_pb11:
    s_add_u32 s86, s86, 1
    s_cmp_ge_u32 s86, 20000
    s_cbranch_scc1 L_po12
    s_sleep 1
    s_load_dwordx16 s[4:19], s[36:37], s78 glc
    s_branch L_pt10
L_po12:
L_fy9:
    s_add_u32 s81, s81, 4294774784
    buffer_load_dwordx4 v[176:179], v2, s[68:71], s81 offen sc1
    buffer_load_dwordx4 v[180:183], v3, s[68:71], s81 offen sc1
    ds_read_b64_tr_b16 v[128:129], v10 offset:0
    ds_read_b64_tr_b16 v[130:131], v10 offset:512
    ds_read_b64_tr_b16 v[132:133], v11 offset:0
    ds_read_b64_tr_b16 v[134:135], v11 offset:512
    v_mfma_f32_32x32x16_bf16 v[48:63], v[168:171], v[16:19], v[48:63]
    s_add_u32 s81, s81, 32768
    buffer_load_dwordx4 v[112:115], v2, s[68:71], s81 offen sc1
    v_mfma_f32_32x32x16_bf16 v[80:95], v[168:171], v[20:23], v[80:95]
    buffer_load_dwordx4 v[116:119], v3, s[68:71], s81 offen sc1
    v_mfma_f32_32x32x16_bf16 v[64:79], v[172:175], v[16:19], v[64:79]
    s_add_u32 s81, s81, 32768
    buffer_load_dwordx4 v[200:203], v2, s[68:71], s81 offen sc1
    v_mfma_f32_32x32x16_bf16 v[96:111], v[172:175], v[20:23], v[96:111]
    s_add_u32 s78, s87, 98304
    v_min_u32 v8, 31, v0
    v_lshlrev_b32_e64 v8, 2, v8
    buffer_load_dword v9, v8, s[52:55], s78 offen sc1
    ds_read_b64_tr_b16 v[248:249], v10 offset:2048
    ds_read_b64_tr_b16 v[250:251], v10 offset:2560
    ds_read_b64_tr_b16 v[252:253], v11 offset:2048
    ds_read_b64_tr_b16 v[254:255], v11 offset:2560
    s_waitcnt lgkmcnt(4)
    v_mfma_f32_32x32x16_bf16 v[48:63], v[40:43], v[24:27], v[48:63]
    buffer_load_dwordx4 v[204:207], v3, s[68:71], s81 offen sc1
    v_mfma_f32_32x32x16_bf16 v[80:95], v[40:43], v[28:31], v[80:95]
    s_add_u32 s81, s81, 32768
    buffer_load_dwordx4 v[136:139], v2, s[68:71], s81 offen sc1
    v_mfma_f32_32x32x16_bf16 v[64:79], v[44:47], v[24:27], v[64:79]
    buffer_load_dwordx4 v[140:143], v3, s[68:71], s81 offen sc1
    v_mfma_f32_32x32x16_bf16 v[96:111], v[44:47], v[28:31], v[96:111]
    ds_read_b64_tr_b16 v[120:121], v10 offset:32768
    ds_read_b64_tr_b16 v[122:123], v10 offset:33280
    ds_read_b64_tr_b16 v[124:125], v11 offset:32768
    ds_read_b64_tr_b16 v[126:127], v11 offset:33280
    s_waitcnt lgkmcnt(4)
    v_mfma_f32_32x32x16_bf16 v[48:63], v[128:131], v[32:35], v[48:63]
    buffer_load_dwordx4 v231, s[48:51], s80 offen offset:1024 lds
    v_mfma_f32_32x32x16_bf16 v[80:95], v[128:131], v[36:39], v[80:95]
    s_add_u32 s81, s81, 32768
    buffer_load_dwordx4 v[208:211], v2, s[68:71], s81 offen sc1
    v_mfma_f32_32x32x16_bf16 v[64:79], v[132:135], v[32:35], v[64:79]
    buffer_load_dwordx4 v[212:215], v3, s[68:71], s81 offen sc1
    v_mfma_f32_32x32x16_bf16 v[96:111], v[132:135], v[36:39], v[96:111]
    v_lshrrev_b32 v232, 3, v0
    v_mul_u32_u24 v232, 4224, v232
    v_and_b32 v233, 7, v0
    v_lshl_add_u32 v232, v233, 4, v232
    v_add_u32 v233, 32768, v232
    v_and_b32 v236, 31, v0
    v_mul_u32_u24 v242, 896, v236
    v_lshlrev_b32 v236, 3, v236
    s_lshl_b32 s72, s64, 1
    s_lshr_b32 s73, s60, 1
    s_add_u32 s72, s72, s73
    s_lshl_b32 s79, s72, 8
    s_add_u32 s79, s79, 32768
    v_add_u32_e64 v237, s82, v14
    v_xor_b32 v238, 4096, v237
    v_xor_b32 v239, 8192, v237
    v_xor_b32 v240, 12288, v237
    ds_read_b64_tr_b16 v[144:145], v10 offset:16384
    ds_read_b64_tr_b16 v[146:147], v10 offset:16896
    ds_read_b64_tr_b16 v[148:149], v11 offset:16384
    ds_read_b64_tr_b16 v[150:151], v11 offset:16896
    s_waitcnt lgkmcnt(4)
    v_mfma_f32_32x32x16_bf16 v[48:63], v[248:251], v[184:187], v[48:63]
    s_add_u32 s81, s81, 32768
    buffer_load_dwordx4 v[216:219], v2, s[68:71], s81 offen sc1
    v_mfma_f32_32x32x16_bf16 v[80:95], v[248:251], v[188:191], v[80:95]
    buffer_load_dwordx4 v[220:223], v3, s[68:71], s81 offen sc1
    v_mfma_f32_32x32x16_bf16 v[64:79], v[252:255], v[184:187], v[64:79]
    s_add_u32 s81, s81, 32768
    buffer_load_dwordx4 v[152:155], v2, s[68:71], s81 offen sc1
    v_mfma_f32_32x32x16_bf16 v[96:111], v[252:255], v[188:191], v[96:111]
    v_lshrrev_b32 v243, 5, v0
    v_lshl_add_u32 v242, v243, 5, v242
    v_lshlrev_b32_e64 v241, 12, v243
    v_bfe_u32 v243, v0, 2, 2
    v_lshl_add_u32 v241, v243, 7, v241
    v_bfe_u32 v243, v0, 4, 1
    v_lshl_add_u32 v241, v243, 5, v241
    v_and_b32 v243, 3, v0
    v_lshl_add_u32 v241, v243, 3, v241
    s_and_b32 s72, s60, 1
    s_lshl_b32 s72, s72, 13
    s_lshr_b32 s73, s60, 1
    s_lshl_b32 s73, s73, 6
    s_add_u32 s72, s72, s73
    v_add_u32_e64 v241, s72, v241
    ds_read_b64_tr_b16 v[160:161], v10 offset:18432
    ds_read_b64_tr_b16 v[162:163], v10 offset:18944
    ds_read_b64_tr_b16 v[164:165], v11 offset:18432
    ds_read_b64_tr_b16 v[166:167], v11 offset:18944
    s_waitcnt lgkmcnt(4)
    v_mfma_f32_32x32x16_bf16 v[48:63], v[120:123], v[192:195], v[48:63]
    buffer_load_dwordx4 v[156:159], v3, s[68:71], s81 offen sc1
    v_mfma_f32_32x32x16_bf16 v[80:95], v[120:123], v[196:199], v[80:95]
    v_mfma_f32_32x32x16_bf16 v[64:79], v[124:127], v[192:195], v[64:79]
    v_mfma_f32_32x32x16_bf16 v[96:111], v[124:127], v[196:199], v[96:111]
    s_waitcnt vmcnt(10)
    v_cmp_ne_u32 vcc, s63, v9
    s_nop 4
    s_cbranch_vccz L_fy13
    s_waitcnt lgkmcnt(0)
    s_load_dwordx16 s[4:19], s[36:37], s78 glc
    s_add_u32 s75, s78, 64
    s_load_dwordx16 s[20:35], s[36:37], s75 glc
    s_mov_b32 s86, 0
L_pt14:
    s_waitcnt lgkmcnt(0)
    s_cmp_eq_u64 s[4:5], s[88:89]
    s_cbranch_scc0 L_pb15
    s_cmp_eq_u64 s[6:7], s[88:89]
    s_cbranch_scc0 L_pb15
    s_cmp_eq_u64 s[8:9], s[88:89]
    s_cbranch_scc0 L_pb15
    s_cmp_eq_u64 s[10:11], s[88:89]
    s_cbranch_scc0 L_pb15
    s_cmp_eq_u64 s[12:13], s[88:89]
    s_cbranch_scc0 L_pb15
    s_cmp_eq_u64 s[14:15], s[88:89]
    s_cbranch_scc0 L_pb15
    s_cmp_eq_u64 s[16:17], s[88:89]
    s_cbranch_scc0 L_pb15
    s_cmp_eq_u64 s[18:19], s[88:89]
    s_cbranch_scc0 L_pb15
    s_cmp_eq_u64 s[20:21], s[88:89]
    s_cbranch_scc0 L_pb15
    s_cmp_eq_u64 s[22:23], s[88:89]
    s_cbranch_scc0 L_pb15
    s_cmp_eq_u64 s[24:25], s[88:89]
    s_cbranch_scc0 L_pb15
    s_cmp_eq_u64 s[26:27], s[88:89]
    s_cbranch_scc0 L_pb15
    s_cmp_eq_u64 s[28:29], s[88:89]
    s_cbranch_scc0 L_pb15
    s_cmp_eq_u64 s[30:31], s[88:89]
    s_cbranch_scc0 L_pb15
    s_cmp_eq_u64 s[32:33], s[88:89]
    s_cbranch_scc0 L_pb15
    s_cmp_eq_u64 s[34:35], s[88:89]
    s_cbranch_scc0 L_pb15
    s_branch L_po16
L_pb15:
    s_add_u32 s86, s86, 1
    s_cmp_ge_u32 s86, 20000
    s_cbranch_scc1 L_po16
    s_sleep 1
    s_load_dwordx16 s[4:19], s[36:37], s78 glc
    s_add_u32 s75, s78, 64
    s_load_dwordx16 s[20:35], s[36:37], s75 glc
    s_branch L_pt14
L_po16:
L_fy13:
    s_lshl_b32 s72, s65, 2
    s_add_u32 s72, s72, s60
    s_mul_i32 s72, s72, 67584
    s_lshl_b32 s73, s64, 7
    s_add_u32 s72, s72, s73
    s_add_u32 s74, s72, 3145728
    s_add_u32 m0, s82, 0
    s_nop 0
    buffer_load_dwordx4 v232, s[52:55], s74 offen sc1 lds
    buffer_load_dwordx4 v233, s[52:55], s74 offen offset:1024 sc1 lds
    buffer_load_dwordx2 v[234:235], v236, s[52:55], s79 offen sc1
    ds_read_b64_tr_b16 v[16:17], v10 offset:34816
    ds_read_b64_tr_b16 v[18:19], v10 offset:35328
    ds_read_b64_tr_b16 v[20:21], v11 offset:34816
    ds_read_b64_tr_b16 v[22:23], v11 offset:35328
    ds_read_b64_tr_b16 v[168:169], v10 offset:49152
    ds_read_b64_tr_b16 v[170:171], v10 offset:49664
    ds_read_b64_tr_b16 v[172:173], v11 offset:49152
    ds_read_b64_tr_b16 v[174:175], v11 offset:49664
    ds_read_b64_tr_b16 v[24:25], v12 offset:0
    ds_read_b64_tr_b16 v[26:27], v12 offset:512
    ds_read_b64_tr_b16 v[28:29], v13 offset:0
    ds_read_b64_tr_b16 v[30:31], v13 offset:512
    s_waitcnt lgkmcnt(12)
    v_mfma_f32_32x32x16_bf16 v[48:63], v[144:147], v[176:179], v[48:63]
    v_mfma_f32_32x32x16_bf16 v[80:95], v[144:147], v[180:183], v[80:95]
    v_mfma_f32_32x32x16_bf16 v[64:79], v[148:151], v[176:179], v[64:79]
    v_mfma_f32_32x32x16_bf16 v[96:111], v[148:151], v[180:183], v[96:111]
    ds_read_b64_tr_b16 v[40:41], v12 offset:2048
    ds_read_b64_tr_b16 v[42:43], v12 offset:2560
    ds_read_b64_tr_b16 v[44:45], v13 offset:2048
    ds_read_b64_tr_b16 v[46:47], v13 offset:2560
    s_waitcnt vmcnt(9)
    ds_read_b64_tr_b16 v[32:33], v10 offset:51200
    ds_read_b64_tr_b16 v[34:35], v10 offset:51712
    ds_read_b64_tr_b16 v[36:37], v11 offset:51200
    ds_read_b64_tr_b16 v[38:39], v11 offset:51712
    s_waitcnt lgkmcnt(8)
    v_mfma_f32_32x32x16_bf16 v[48:63], v[160:163], v[112:115], v[48:63]
    v_mfma_f32_32x32x16_bf16 v[80:95], v[160:163], v[116:119], v[80:95]
    v_mfma_f32_32x32x16_bf16 v[64:79], v[164:167], v[112:115], v[64:79]
    v_mfma_f32_32x32x16_bf16 v[96:111], v[164:167], v[116:119], v[96:111]
    s_waitcnt lgkmcnt(0)
    v_mfma_f32_32x32x16_bf16 v[48:63], v[16:19], v[200:203], v[48:63]
    v_mfma_f32_32x32x16_bf16 v[80:95], v[16:19], v[204:207], v[80:95]
    v_mfma_f32_32x32x16_bf16 v[64:79], v[20:23], v[200:203], v[64:79]
    v_mfma_f32_32x32x16_bf16 v[96:111], v[20:23], v[204:207], v[96:111]
    s_waitcnt lgkmcnt(0)
    v_mfma_f32_32x32x16_bf16 v[96:111], v[172:175], v[140:143], v[96:111]
    s_waitcnt vmcnt(7)
    v_mfma_f32_32x32x16_bf16 v[96:111], v[28:31], v[212:215], v[96:111]
    s_waitcnt vmcnt(5)
    v_mfma_f32_32x32x16_bf16 v[96:111], v[44:47], v[220:223], v[96:111]
    s_waitcnt vmcnt(3)
    v_mfma_f32_32x32x16_bf16 v[96:111], v[36:39], v[156:159], v[96:111]
    v_mfma_f32_32x32x16_bf16 v[80:95], v[168:171], v[140:143], v[80:95]
    v_mfma_f32_32x32x16_bf16 v[80:95], v[24:27], v[212:215], v[80:95]
    s_nop 9
    ds_write_b128 v237, v[96:99] offset:49152
    v_mfma_f32_32x32x16_bf16 v[80:95], v[40:43], v[220:223], v[80:95]
    ds_write_b128 v237, v[100:103] offset:50176
    v_mfma_f32_32x32x16_bf16 v[80:95], v[32:35], v[156:159], v[80:95]
    ds_write_b128 v237, v[104:107] offset:51200
    ds_write_b128 v237, v[108:111] offset:52224
    v_mfma_f32_32x32x16_bf16 v[64:79], v[172:175], v[136:139], v[64:79]
    v_mfma_f32_32x32x16_bf16 v[64:79], v[28:31], v[208:211], v[64:79]
    s_nop 7
    ds_write_b128 v237, v[80:83] offset:32768
    v_mfma_f32_32x32x16_bf16 v[64:79], v[44:47], v[216:219], v[64:79]
    ds_write_b128 v237, v[84:87] offset:33792
    v_mfma_f32_32x32x16_bf16 v[64:79], v[36:39], v[152:155], v[64:79]
    ds_write_b128 v237, v[88:91] offset:34816
    ds_write_b128 v237, v[92:95] offset:35840
    v_mfma_f32_32x32x16_bf16 v[48:63], v[168:171], v[136:139], v[48:63]
    v_mfma_f32_32x32x16_bf16 v[48:63], v[24:27], v[208:211], v[48:63]
    s_nop 7
    ds_write_b128 v237, v[64:67] offset:16384
    v_mfma_f32_32x32x16_bf16 v[48:63], v[40:43], v[216:219], v[48:63]
    ds_write_b128 v237, v[68:71] offset:17408
    v_mfma_f32_32x32x16_bf16 v[48:63], v[32:35], v[152:155], v[48:63]
    ds_write_b128 v237, v[72:75] offset:18432
    ds_write_b128 v237, v[76:79] offset:19456
    s_waitcnt vmcnt(0) lgkmcnt(0)
    s_barrier
    ds_read_b128 v[112:115], v238 offset:16384
    ds_read_b128 v[116:119], v238 offset:17408
    ds_read_b128 v[120:123], v238 offset:18432
    ds_read_b128 v[124:127], v238 offset:19456
    ds_read_b128 v[128:131], v239 offset:32768
    ds_read_b128 v[132:135], v239 offset:33792
    ds_read_b128 v[136:139], v239 offset:34816
    ds_read_b128 v[140:143], v239 offset:35840
    ds_read_b128 v[144:147], v240 offset:49152
    ds_read_b128 v[148:151], v240 offset:50176
    ds_read_b128 v[152:155], v240 offset:51200
    ds_read_b128 v[156:159], v240 offset:52224
    s_mov_b32 s86, 0
L_gt17:
    v_cmp_ne_u32 vcc, s63, v235
    s_nop 4
    s_cbranch_vccz L_go18
    s_add_u32 s86, s86, 1
    s_cmp_ge_u32 s86, 20000
    s_cbranch_scc1 L_go18
    buffer_load_dwordx2 v[234:235], v236, s[52:55], s79 offen sc1
    s_waitcnt vmcnt(0)
    s_branch L_gt17
L_go18:
    s_waitcnt lgkmcnt(8)
    ds_read_b64_tr_b16 v[16:17], v241 offset:0
    ds_read_b64_tr_b16 v[18:19], v241 offset:512
    ds_read_b64_tr_b16 v[20:21], v241 offset:1024
    ds_read_b64_tr_b16 v[22:23], v241 offset:1536
    v_lshlrev_b32 v244, 16, v234
    v_and_b32 v246, 0xffff0000, v234
    v_pk_add_f32 v[48:49], v[48:49], v[112:113]
    v_pk_add_f32 v[50:51], v[50:51], v[114:115]
    v_pk_add_f32 v[52:53], v[52:53], v[116:117]
    v_pk_add_f32 v[54:55], v[54:55], v[118:119]
    v_pk_add_f32 v[56:57], v[56:57], v[120:121]
    v_pk_add_f32 v[58:59], v[58:59], v[122:123]
    v_pk_add_f32 v[60:61], v[60:61], v[124:125]
    v_pk_add_f32 v[62:63], v[62:63], v[126:127]
    s_waitcnt lgkmcnt(8)
    v_pk_add_f32 v[48:49], v[48:49], v[128:129]
    v_pk_add_f32 v[50:51], v[50:51], v[130:131]
    v_pk_add_f32 v[52:53], v[52:53], v[132:133]
    v_pk_add_f32 v[54:55], v[54:55], v[134:135]
    v_pk_add_f32 v[56:57], v[56:57], v[136:137]
    v_pk_add_f32 v[58:59], v[58:59], v[138:139]
    v_pk_add_f32 v[60:61], v[60:61], v[140:141]
    v_pk_add_f32 v[62:63], v[62:63], v[142:143]
    s_waitcnt lgkmcnt(4)
    v_pk_add_f32 v[48:49], v[48:49], v[144:145]
    v_pk_add_f32 v[50:51], v[50:51], v[146:147]
    v_pk_add_f32 v[52:53], v[52:53], v[148:149]
    v_pk_add_f32 v[54:55], v[54:55], v[150:151]
    v_pk_add_f32 v[56:57], v[56:57], v[152:153]
    v_pk_add_f32 v[58:59], v[58:59], v[154:155]
    v_pk_add_f32 v[60:61], v[60:61], v[156:157]
    v_pk_add_f32 v[62:63], v[62:63], v[158:159]
    s_waitcnt lgkmcnt(0)
    v_lshlrev_b32 v112, 16, v16
    v_and_b32 v113, 0xffff0000, v16
    v_pk_mul_f32 v[48:49], v[48:49], v[246:247] op_sel_hi:[1,0]
    v_lshlrev_b32_e64 v114, 16, v17
    v_and_b32 v115, 0xffff0000, v17
    v_pk_mul_f32 v[50:51], v[50:51], v[246:247] op_sel_hi:[1,0]
    v_lshlrev_b32_e64 v116, 16, v18
    v_and_b32 v117, 0xffff0000, v18
    v_pk_mul_f32 v[52:53], v[52:53], v[246:247] op_sel_hi:[1,0]
    v_lshlrev_b32_e64 v118, 16, v19
    v_and_b32 v119, 0xffff0000, v19
    v_pk_mul_f32 v[54:55], v[54:55], v[246:247] op_sel_hi:[1,0]
    v_pk_fma_f32 v[48:49], v[112:113], v[244:245], v[48:49] op_sel_hi:[1,0,1]
    v_pk_fma_f32 v[50:51], v[114:115], v[244:245], v[50:51] op_sel_hi:[1,0,1]
    v_pk_fma_f32 v[52:53], v[116:117], v[244:245], v[52:53] op_sel_hi:[1,0,1]
    v_pk_fma_f32 v[54:55], v[118:119], v[244:245], v[54:55] op_sel_hi:[1,0,1]
    v_cvt_pk_bf16_f32 v24, v48, v49
    v_cvt_pk_bf16_f32 v25, v50, v51
    v_cvt_pk_bf16_f32 v26, v52, v53
    v_cvt_pk_bf16_f32 v27, v54, v55
    buffer_store_dwordx4 v[24:27], v242, s[56:59], s99 offen offset:0
    v_lshlrev_b32_e64 v120, 16, v20
    v_and_b32 v121, 0xffff0000, v20
    v_pk_mul_f32 v[56:57], v[56:57], v[246:247] op_sel_hi:[1,0]
    v_lshlrev_b32_e64 v122, 16, v21
    v_and_b32 v123, 0xffff0000, v21
    v_pk_mul_f32 v[58:59], v[58:59], v[246:247] op_sel_hi:[1,0]
    v_lshlrev_b32_e64 v124, 16, v22
    v_and_b32 v125, 0xffff0000, v22
    v_pk_mul_f32 v[60:61], v[60:61], v[246:247] op_sel_hi:[1,0]
    v_lshlrev_b32_e64 v126, 16, v23
    v_and_b32 v127, 0xffff0000, v23
    v_pk_mul_f32 v[62:63], v[62:63], v[246:247] op_sel_hi:[1,0]
    v_pk_fma_f32 v[56:57], v[120:121], v[244:245], v[56:57] op_sel_hi:[1,0,1]
    v_pk_fma_f32 v[58:59], v[122:123], v[244:245], v[58:59] op_sel_hi:[1,0,1]
    v_pk_fma_f32 v[60:61], v[124:125], v[244:245], v[60:61] op_sel_hi:[1,0,1]
    v_pk_fma_f32 v[62:63], v[126:127], v[244:245], v[62:63] op_sel_hi:[1,0,1]
    v_cvt_pk_bf16_f32 v28, v56, v57
    v_cvt_pk_bf16_f32 v29, v58, v59
    v_cvt_pk_bf16_f32 v30, v60, v61
    v_cvt_pk_bf16_f32 v31, v62, v63
    buffer_store_dwordx4 v[28:31], v242, s[56:59], s99 offen offset:16
    s_endpgm
L_ssm:
    s_setprio 2
    s_and_b32 s92, s2, 255
    s_lshl_b32 s72, s92, 10
    s_lshl_b32 s73, s60, 8
    s_add_u32 s72, s72, s73
    v_lshl_add_u32 v62, v0, 2, s72
    s_lshr_b32 s61, s60, 1
    s_and_b32 s62, s60, 1
    s_lshl_b32 s78, s92, 1
    s_add_u32 s78, s78, s61
    v_lshrrev_b32 v1, 3, v0
    v_mul_u32_u24 v2, 896, v1
    v_and_b32_e64 v13, 7, v0
    v_lshl_add_u32 v2, v13, 4, v2
    v_add_u32 v3, 6144, v2
    s_lshl_b32 s72, s64, 2
    s_add_u32 s72, s72, s60
    s_mul_i32 s87, s72, 14336
    s_lshl_b32 s73, s65, 7
    s_add_u32 s87, s87, s73
    s_lshl_b32 s72, s60, 11
    s_add_u32 m0, s72, 65536
    v_and_b32 v16, 31, v0
    v_lshrrev_b32 v17, 5, v0
    v_lshlrev_b32 v17, 3, v17
    v_sub_u32 v16, v16, v17
    v_and_b32 v17, 1, v0
    v_lshlrev_b32 v17, 4, v17
    v_mov_b32 v18, 0x3c00
    v_lshlrev_b32 v17, v17, v18
    v_ashrrev_i32 v16, 1, v16
    v_cmp_eq_u32 vcc, 0, v16
    s_nop 1
    v_cndmask_b32 v240, 0, v17, vcc
    v_cmp_eq_u32 vcc, 1, v16
    s_nop 1
    v_cndmask_b32 v241, 0, v17, vcc
    v_cmp_eq_u32 vcc, 2, v16
    s_nop 1
    v_cndmask_b32 v242, 0, v17, vcc
    v_cmp_eq_u32 vcc, 3, v16
    s_nop 1
    v_cndmask_b32 v243, 0, v17, vcc
    v_cmp_eq_u32 vcc, 8, v16
    s_nop 1
    v_cndmask_b32 v244, 0, v17, vcc
    v_cmp_eq_u32 vcc, 9, v16
    s_nop 1
    v_cndmask_b32 v245, 0, v17, vcc
    v_cmp_eq_u32 vcc, 10, v16
    s_nop 1
    v_cndmask_b32 v246, 0, v17, vcc
    v_cmp_eq_u32 vcc, 11, v16
    s_nop 1
    v_cndmask_b32 v247, 0, v17, vcc
    v_lshrrev_b32 v232, 4, v0
    v_bfe_u32 v233, v0, 2, 2
    v_and_b32_e64 v234, 3, v0
    v_and_b32 v235, 15, v0
    s_waitcnt lgkmcnt(0)
    s_load_dword s63, s[36:37], 0
    global_load_dword v56, v62, s[6:7] nt
    global_load_dword v57, v62, s[8:9] nt
    global_load_dword v58, v62, s[10:11] nt
    global_load_dword v59, v62, s[12:13] nt
    global_load_dword v60, v62, s[14:15] nt
    global_load_dword v61, v62, s[16:17] nt
    s_lshl_b32 s72, s92, 2
    s_load_dword s93, s[18:19], s72
    s_load_dword s94, s[20:21], s72
    s_mov_b32 s40, s4
    s_mov_b32 s41, s5
    s_mov_b32 s42, 1835008
    s_mov_b32 s43, 0x20000
    buffer_load_dwordx4 v2, s[40:43], s87 offen lds
    buffer_load_dwordx4 v3, s[40:43], s87 offen offset:1024 lds
    s_mov_b32 s52, s36
    s_mov_b32 s53, s37
    s_mov_b32 s54, 16777216
    s_mov_b32 s55, 0x20000
    v_lshlrev_b32 v248, 10, v232
    v_lshl_add_u32 v248, v233, 7, v248
    v_lshl_add_u32 v248, v234, 3, v248
    s_lshl_b32 s72, s60, 5
    s_add_u32 s72, s72, 65536
    v_add_u32 v248, s72, v248
    s_add_u32 s72, s82, 49152
    v_mul_u32_u24 v249, 144, v235
    v_lshl_add_u32 v249, v232, 4, v249
    v_add_u32_e64 v249, s72, v249
    v_mul_u32_u24 v250, 144, v1
    v_lshl_add_u32 v250, v13, 4, v250
    v_add_u32_e64 v250, s72, v250
    v_mul_u32_u24 v251, 4224, v1
    v_lshl_add_u32 v251, v13, 4, v251
    s_lshl_b32 s72, s65, 2
    s_add_u32 s72, s72, s60
    s_mul_i32 s72, s72, 67584
    s_lshl_b32 s73, s64, 7
    s_add_u32 s72, s72, s73
    s_add_u32 s85, s72, 1048576
    s_add_u32 s83, s85, 33792
    v_lshlrev_b32 v14, 7, v0
    v_lshlrev_b32 v15, 7, v0
    s_lshl_b32 s72, s65, 12
    s_lshl_b32 s73, s64, 2
    s_add_u32 s72, s72, s73
    s_add_u32 s72, s72, 65536
    s_cmp_eq_u32 s60, 0
    s_cselect_b32 s75, 32, 0
    v_add_u32 v14, s72, v14
    v_cmp_gt_u32 vcc, s75, v0
    s_nop 1
    v_cndmask_b32 v14, 2.0, v14, vcc
    s_lshr_b32 s72, s92, 5
    s_lshl_b32 s72, s72, 12
    s_and_b32 s73, s92, 31
    s_lshl_b32 s73, s73, 2
    s_add_u32 s72, s72, s73
    s_add_u32 s72, s72, 98304
    s_cmp_eq_u32 s60, 0
    s_cselect_b32 s75, 32, 0
    v_add_u32 v15, s72, v15
    v_cmp_gt_u32 vcc, s75, v0
    s_nop 1
    v_cndmask_b32 v15, 2.0, v15, vcc
    s_mul_i32 s79, s61, 16640
    s_add_u32 s79, s79, 0
    s_mul_i32 s80, s61, 4608
    s_add_u32 s80, s80, 33280
    s_lshl_b32 s81, s92, 7
    s_add_u32 s81, s81, 65536
    v_lshlrev_b32 v4, 4, v0
    v_lshrrev_b32 v224, 5, v0
    v_bfe_u32 v225, v0, 4, 1
    v_lshlrev_b32_e64 v225, 4, v225
    v_mul_u32_u24 v6, 4160, v233
    v_lshl_add_u32 v6, v224, 5, v6
    v_lshl_add_u32 v6, v234, 3, v6
    v_sub_u32 v6, v6, v225
    s_lshl_b32 s72, s62, 8
    s_add_u32 s73, s79, s72
    s_add_u32 s73, s73, 24
    v_add_u32 v6, s73, v6
    v_sub_u32 v226, v235, v224
    v_lshlrev_b32 v226, 5, v226
    v_add_u32 v7, v226, v225
    s_sub_u32 s73, s80, s72
    s_add_u32 s73, s73, 320
    v_add_u32 v7, s73, v7
    s_add_u32 s72, s82, 49152
    v_add_u32 v8, s72, v4
    v_xor_b32 v9, 0x1000, v8
    v_lshlrev_b32 v11, 5, v235
    v_lshl_add_u32 v11, v232, 3, v11
    s_lshl_b32 s73, s62, 11
    s_add_u32 s73, s73, s79
    v_add_u32 v10, s73, v4
    v_add_u32 v12, s73, v11
    s_add_u32 s72, s72, 16384
    v_add_u32 v11, s72, v11
    v_mov_b32 v64, 0
    v_mov_b32 v65, 0
    v_mov_b32 v66, 0
    v_mov_b32 v67, 0
    v_mov_b32 v68, 0
    v_mov_b32 v69, 0
    v_mov_b32 v70, 0
    v_mov_b32 v71, 0
    v_mov_b32 v72, 0
    v_mov_b32 v73, 0
    v_mov_b32 v74, 0
    v_mov_b32 v75, 0
    v_mov_b32 v76, 0
    v_mov_b32 v77, 0
    v_mov_b32 v78, 0
    v_mov_b32 v79, 0
    s_waitcnt lgkmcnt(0)
    s_mul_i32 s63, s63, 0x9E3779B1
    s_add_u32 s63, s63, 0x7F4A7C15
    s_mov_b32 s88, s63
    s_mov_b32 s89, s63
    v_mov_b32 v5, s63
    s_lshl_b32 s72, s61, 4
    s_lshr_b32 s94, s94, s72
    s_lshl_b32 s94, s94, 16
    s_lshr_b32 s93, s93, s72
    s_lshl_b32 s93, s93, 16
    v_mov_b32 v41, 1069066811
    v_mov_b32 v45, s93
    v_mul_f32 v42, v45, v41
    v_fma_f32 v43, v45, v41, -v42
    v_fmac_f32 v43, 0x32a57060, v45
    v_exp_f32_e64 v42, v42
    v_mul_f32 v43, 0x3f317218, v43
    v_fma_f32 v42, v42, v43, v42
    v_cvt_pk_bf16_f32 v42, v42, v42
    v_lshlrev_b32 v63, 16, v42
    v_mul_f32 v43, v63, v41
    v_mul_f32 v44, 0.15915494, v63
    v_readfirstlane_b32 s95, v43
    v_readfirstlane_b32 s96, v44
    s_waitcnt vmcnt(2)
    v_lshlrev_b32 v20, 16, v58
    v_and_b32 v24, 0xffff0000, v58
    v_lshlrev_b32 v21, 16, v59
    v_and_b32 v25, 0xffff0000, v59
    v_lshlrev_b32 v22, 16, v60
    v_and_b32 v26, 0xffff0000, v60
    v_lshlrev_b32 v23, 16, v61
    v_and_b32 v27, 0xffff0000, v61
    v_mul_f32 v28, v23, v21
    v_mul_f32 v29, v23, v20
    v_fma_f32 v17, v22, v21, v29
    v_fma_f32 v16, v22, v20, -v28
    v_mul_f32 v30, v27, v25
    v_mul_f32 v31, v27, v24
    v_fma_f32 v19, v26, v25, v31
    v_fma_f32 v18, v26, v24, -v30
    v_max3_f32 v20, abs(v16), abs(v17), abs(v18)
    v_max_f32 v20, abs(v19), v20
    v_lshlrev_b32_e64 v21, 16, v56
    v_and_b32 v22, 0xffff0000, v56
    v_max3_f32 v21, v21, v22, 0
    v_max_f32_dpp v20, v20, v20 row_shr:1 row_mask:0xf bank_mask:0xf
    s_nop 0
    v_max_f32_dpp v21, v21, v21 row_shr:1 row_mask:0xf bank_mask:0xf
    v_max_f32_dpp v20, v20, v20 row_shr:2 row_mask:0xf bank_mask:0xf
    s_nop 0
    v_max_f32_dpp v21, v21, v21 row_shr:2 row_mask:0xf bank_mask:0xf
    v_max_f32_dpp v20, v20, v20 row_shr:4 row_mask:0xf bank_mask:0xf
    s_nop 0
    v_max_f32_dpp v21, v21, v21 row_shr:4 row_mask:0xf bank_mask:0xf
    v_max_f32_dpp v20, v20, v20 row_shr:8 row_mask:0xf bank_mask:0xf
    s_nop 0
    v_max_f32_dpp v21, v21, v21 row_shr:8 row_mask:0xf bank_mask:0xf
    v_max_f32_dpp v20, v20, v20 row_bcast:15 row_mask:0xa bank_mask:0xf
    s_nop 0
    v_max_f32_dpp v21, v21, v21 row_bcast:15 row_mask:0xa bank_mask:0xf
    v_max_f32_dpp v20, v20, v20 row_bcast:31 row_mask:0xc bank_mask:0xf
    s_nop 0
    v_max_f32_dpp v21, v21, v21 row_bcast:31 row_mask:0xc bank_mask:0xf
    s_nop 0
    v_readlane_b32 s93, v21, 63
    s_nop 1
    v_mov_b32 v62, s93
    v_mul_f32 v62, s95, v62
    v_readlane_b32 s72, v20, 63
    s_nop 0
    s_lshr_b32 s72, s72, 23
    s_max_u32 s72, s72, 8
    s_sub_u32 s73, 258, s72
    s_lshl_b32 s73, s73, 23
    s_sub_u32 s72, s72, 4
    s_lshl_b32 s72, s72, 23
    v_mul_f32 v16, s73, v16
    v_mul_f32 v17, s73, v17
    v_mul_f32 v18, s73, v18
    v_mul_f32 v19, s73, v19
    v_mul_f32 v63, s72, v63
    s_nop 0
    v_readfirstlane_b32 s97, v63
    s_mov_b32 s84, 0
L_kround:
    v_lshlrev_b32 v20, 16, v56
    v_lshlrev_b32 v21, 16, v57
    v_lshrrev_b32 v56, 16, v56
    v_lshrrev_b32 v57, 16, v57
    v_fma_f32 v20, s95, v20, -v62
    v_mul_f32_e64 v21, s96, v21
    v_mul_f32 v22, 0x42000000, v20
    v_mul_f32 v23, 0x42000000, v21
    v_exp_f32 v20, v20
    v_fract_f32 v21, v21
    v_exp_f32 v22, v22
    v_fract_f32 v23, v23
    v_cos_f32 v32, v21
    v_sin_f32 v33, v21
    v_cos_f32 v34, v23
    v_sin_f32 v35, v23
    v_mul_f32 v32, v32, v20
    v_mul_f32 v33, v33, v20
    v_mul_f32 v34, v34, v22
    v_mul_f32 v35, v35, v22
    v_cvt_pk_f16_f32 v40, v32, v33
    v_cvt_pk_f16_f32 v43, v34, v35
    v_mul_f32 v36, v33, v33
    v_add_f32 v37, v32, v32
    v_fma_f32 v32, v32, v32, -v36
    v_mul_f32 v33, v37, v33
    v_mul_f32 v36, v17, v33
    v_mul_f32_e64 v37, v17, v32
    v_fma_f32 v51, v16, v33, v37
    v_fma_f32 v50, v16, v32, -v36
    v_mul_f32 v36, v35, v35
    v_add_f32 v37, v34, v34
    v_fma_f32 v34, v34, v34, -v36
    v_mul_f32 v35, v37, v35
    v_cvt_pk_f16_f32 v44, v34, v35
    v_mul_f32 v36, v33, v33
    v_add_f32 v37, v32, v32
    v_fma_f32 v32, v32, v32, -v36
    v_mul_f32 v33, v37, v33
    v_cvt_pk_f16_f32 v41, v32, v33
    v_mul_f32 v36, v35, v35
    v_add_f32 v37, v34, v34
    v_fma_f32 v34, v34, v34, -v36
    v_mul_f32 v35, v37, v35
    v_cvt_pk_f16_f32 v45, v34, v35
    v_mul_f32 v36, v33, v33
    v_add_f32 v37, v32, v32
    v_fma_f32 v32, v32, v32, -v36
    v_mul_f32 v33, v37, v33
    v_mul_f32 v36, v17, v33
    v_mul_f32 v37, v17, v32
    v_fma_f32 v53, v16, v33, v37
    v_fma_f32 v52, v16, v32, -v36
    v_cvt_pk_f16_f32 v80, 1.0, v32
    v_cvt_pk_f16_f32 v96, 0, -v33
    v_mul_f32 v36, v35, v35
    v_add_f32 v37, v34, v34
    v_fma_f32 v34, v34, v34, -v36
    v_mul_f32 v35, v37, v35
    v_cvt_pk_f16_f32 v46, v34, v35
    v_mul_f32 v36, v35, v35
    v_add_f32 v37, v34, v34
    v_fma_f32 v34, v34, v34, -v36
    v_mul_f32 v35, v37, v35
    v_cvt_pk_f16_f32 v47, v34, v35
    v_mul_f32 v36, v35, v35
    v_add_f32 v37, v34, v34
    v_fma_f32 v34, v34, v34, -v36
    v_mul_f32 v35, v37, v35
    v_cvt_pk_f16_f32 v48, v34, v35
    v_mul_f32 v36, v33, v33
    v_add_f32 v37, v32, v32
    v_fma_f32 v32, v32, v32, -v36
    v_mul_f32 v33, v37, v33
    v_cvt_pk_f16_f32 v42, v32, v33
    v_cvt_pk_f16_f32 v176, v16, v50
    v_cvt_pk_f16_f32 v192, v17, v51
    v_cvt_pk_f16_f32 v38, v16, v52
    v_cvt_pk_f16_f32 v39, v17, v53
    v_mov_b32 v16, v18
    v_mov_b32 v17, v19
    v_pk_mul_f16 v177, v176, v40 op_sel_hi:[1,0]
    v_pk_mul_f16 v193, v192, v40 op_sel_hi:[1,0]
    v_pk_fma_f16 v177, v192, v40, v177 op_sel:[0,1,0] op_sel_hi:[1,1,1] neg_lo:[1,0,0] neg_hi:[1,0,0]
    v_pk_fma_f16 v193, v176, v40, v193 op_sel:[0,1,0] op_sel_hi:[1,1,1]
    v_pk_mul_f16 v178, v176, v41 op_sel_hi:[1,0]
    v_pk_mul_f16 v194, v192, v41 op_sel_hi:[1,0]
    v_pk_fma_f16 v178, v192, v41, v178 op_sel:[0,1,0] op_sel_hi:[1,1,1] neg_lo:[1,0,0] neg_hi:[1,0,0]
    v_pk_fma_f16 v194, v176, v41, v194 op_sel:[0,1,0] op_sel_hi:[1,1,1]
    v_pk_mul_f16 v179, v177, v41 op_sel_hi:[1,0]
    v_pk_mul_f16 v195, v193, v41 op_sel_hi:[1,0]
    v_pk_fma_f16 v179, v193, v41, v179 op_sel:[0,1,0] op_sel_hi:[1,1,1] neg_lo:[1,0,0] neg_hi:[1,0,0]
    v_pk_fma_f16 v195, v177, v41, v195 op_sel:[0,1,0] op_sel_hi:[1,1,1]
    v_pk_mul_f16 v180, v176, v46 op_sel_hi:[1,0]
    v_pk_mul_f16 v196, v192, v46 op_sel_hi:[1,0]
    v_pk_fma_f16 v180, v192, v46, v180 op_sel:[0,1,0] op_sel_hi:[1,1,1] neg_lo:[1,0,0] neg_hi:[1,0,0]
    v_pk_fma_f16 v196, v176, v46, v196 op_sel:[0,1,0] op_sel_hi:[1,1,1]
    v_pk_mul_f16 v182, v178, v46 op_sel_hi:[1,0]
    v_pk_mul_f16 v198, v194, v46 op_sel_hi:[1,0]
    v_pk_fma_f16 v182, v194, v46, v182 op_sel:[0,1,0] op_sel_hi:[1,1,1] neg_lo:[1,0,0] neg_hi:[1,0,0]
    v_pk_fma_f16 v198, v178, v46, v198 op_sel:[0,1,0] op_sel_hi:[1,1,1]
    v_pk_mul_f16 v183, v38, v46 op_sel_hi:[1,0]
    v_pk_mul_f16 v199, v39, v46 op_sel_hi:[1,0]
    v_pk_fma_f16 v183, v39, v46, v183 op_sel:[0,1,0] op_sel_hi:[1,1,1] neg_lo:[1,0,0] neg_hi:[1,0,0]
    v_pk_fma_f16 v199, v38, v46, v199 op_sel:[0,1,0] op_sel_hi:[1,1,1]
    v_alignbit_b32 v181, v182, v182, 16
    v_alignbit_b32 v197, v198, v198, 16
    v_pk_mul_f16 v184, v38, v47 op_sel_hi:[1,0]
    v_pk_mul_f16 v200, v39, v47 op_sel_hi:[1,0]
    v_pk_fma_f16 v184, v39, v47, v184 op_sel:[0,1,0] op_sel_hi:[1,1,1] neg_lo:[1,0,0] neg_hi:[1,0,0]
    v_pk_fma_f16 v200, v38, v47, v200 op_sel:[0,1,0] op_sel_hi:[1,1,1]
    v_pk_mul_f16 v185, v178, v47 op_sel_hi:[1,0]
    v_pk_mul_f16 v201, v194, v47 op_sel_hi:[1,0]
    v_pk_fma_f16 v185, v194, v47, v185 op_sel:[0,1,0] op_sel_hi:[1,1,1] neg_lo:[1,0,0] neg_hi:[1,0,0]
    v_pk_fma_f16 v201, v178, v47, v201 op_sel:[0,1,0] op_sel_hi:[1,1,1]
    s_cmp_eq_u32 s84, 0
    s_cbranch_scc1 L_sr19
    s_waitcnt vmcnt(0)
    s_barrier
    buffer_store_dword v5, v14, s[52:55], 0 offen sc1
L_sr19:
    v_pk_mul_f16 v186, v183, v47 op_sel_hi:[1,0]
    v_pk_mul_f16 v202, v199, v47 op_sel_hi:[1,0]
    v_pk_fma_f16 v186, v199, v47, v186 op_sel:[0,1,0] op_sel_hi:[1,1,1] neg_lo:[1,0,0] neg_hi:[1,0,0]
    v_pk_fma_f16 v202, v183, v47, v202 op_sel:[0,1,0] op_sel_hi:[1,1,1]
    v_pk_mul_f16 v187, v182, v47 op_sel_hi:[1,0]
    v_pk_mul_f16 v203, v198, v47 op_sel_hi:[1,0]
    v_pk_fma_f16 v187, v198, v47, v187 op_sel:[0,1,0] op_sel_hi:[1,1,1] neg_lo:[1,0,0] neg_hi:[1,0,0]
    v_pk_fma_f16 v203, v182, v47, v203 op_sel:[0,1,0] op_sel_hi:[1,1,1]
    v_pk_mul_f16 v188, v38, v48 op_sel_hi:[1,0]
    v_pk_mul_f16 v204, v39, v48 op_sel_hi:[1,0]
    v_pk_fma_f16 v188, v39, v48, v188 op_sel:[0,1,0] op_sel_hi:[1,1,1] neg_lo:[1,0,0] neg_hi:[1,0,0]
    v_pk_fma_f16 v204, v38, v48, v204 op_sel:[0,1,0] op_sel_hi:[1,1,1]
    v_pk_mul_f16 v189, v183, v48 op_sel_hi:[1,0]
    v_pk_mul_f16 v205, v199, v48 op_sel_hi:[1,0]
    v_pk_fma_f16 v189, v199, v48, v189 op_sel:[0,1,0] op_sel_hi:[1,1,1] neg_lo:[1,0,0] neg_hi:[1,0,0]
    v_pk_fma_f16 v205, v183, v48, v205 op_sel:[0,1,0] op_sel_hi:[1,1,1]
    v_pk_mul_f16 v190, v184, v48 op_sel_hi:[1,0]
    v_pk_mul_f16 v206, v200, v48 op_sel_hi:[1,0]
    v_pk_fma_f16 v190, v200, v48, v190 op_sel:[0,1,0] op_sel_hi:[1,1,1] neg_lo:[1,0,0] neg_hi:[1,0,0]
    v_pk_fma_f16 v206, v184, v48, v206 op_sel:[0,1,0] op_sel_hi:[1,1,1]
    v_pk_mul_f16 v191, v186, v48 op_sel_hi:[1,0]
    v_pk_mul_f16 v207, v202, v48 op_sel_hi:[1,0]
    v_pk_fma_f16 v191, v202, v48, v191 op_sel:[0,1,0] op_sel_hi:[1,1,1] neg_lo:[1,0,0] neg_hi:[1,0,0]
    v_pk_fma_f16 v207, v186, v48, v207 op_sel:[0,1,0] op_sel_hi:[1,1,1]
    v_permlane32_swap_b32 v176, v180
    v_permlane32_swap_b32 v177, v181
    v_permlane32_swap_b32 v178, v182
    v_permlane32_swap_b32 v179, v183
    v_permlane32_swap_b32 v184, v188
    v_permlane32_swap_b32 v185, v189
    v_permlane32_swap_b32 v186, v190
    v_permlane32_swap_b32 v187, v191
    v_permlane32_swap_b32 v192, v196
    v_permlane32_swap_b32 v193, v197
    v_mfma_f32_32x32x16_f16 v[208:223], v[176:179], v[240:243], 0
    v_permlane32_swap_b32 v194, v198
    v_permlane32_swap_b32 v195, v199
    v_permlane32_swap_b32 v200, v204
    v_permlane32_swap_b32 v201, v205
    v_permlane32_swap_b32 v202, v206
    v_permlane32_swap_b32 v203, v207
    v_mfma_f32_32x32x16_f16 v[208:223], v[184:187], v[244:247], v[208:223]
    v_pk_mul_f16 v81, v80, v42 op_sel_hi:[1,0]
    v_pk_mul_f16 v97, v96, v42 op_sel_hi:[1,0]
    v_pk_fma_f16 v81, v96, v42, v81 op_sel:[0,1,0] op_sel_hi:[1,1,1]
    v_pk_fma_f16 v97, v80, v42, v97 op_sel:[0,1,0] op_sel_hi:[1,1,1] neg_lo:[1,0,0] neg_hi:[1,0,0]
    v_pk_mul_f16 v82, v80, v43 op_sel_hi:[1,0]
    v_pk_mul_f16 v98, v96, v43 op_sel_hi:[1,0]
    v_mfma_f32_32x32x16_f16 v[224:239], v[180:183], v[240:243], 0
    v_pk_fma_f16 v82, v96, v43, v82 op_sel:[0,1,0] op_sel_hi:[1,1,1]
    v_pk_fma_f16 v98, v80, v43, v98 op_sel:[0,1,0] op_sel_hi:[1,1,1] neg_lo:[1,0,0] neg_hi:[1,0,0]
    v_pk_mul_f16 v83, v81, v43 op_sel_hi:[1,0]
    v_pk_mul_f16 v99, v97, v43 op_sel_hi:[1,0]
    v_pk_fma_f16 v83, v97, v43, v83 op_sel:[0,1,0] op_sel_hi:[1,1,1]
    v_pk_fma_f16 v99, v81, v43, v99 op_sel:[0,1,0] op_sel_hi:[1,1,1] neg_lo:[1,0,0] neg_hi:[1,0,0]
    v_mfma_f32_32x32x16_f16 v[224:239], v[188:191], v[244:247], v[224:239]
    v_pk_mul_f16 v84, v80, v44 op_sel_hi:[1,0]
    v_pk_mul_f16 v100, v96, v44 op_sel_hi:[1,0]
    v_pk_fma_f16 v84, v96, v44, v84 op_sel:[0,1,0] op_sel_hi:[1,1,1]
    v_pk_fma_f16 v100, v80, v44, v100 op_sel:[0,1,0] op_sel_hi:[1,1,1] neg_lo:[1,0,0] neg_hi:[1,0,0]
    v_pk_mul_f16 v85, v81, v44 op_sel_hi:[1,0]
    v_pk_mul_f16 v101, v97, v44 op_sel_hi:[1,0]
    v_mfma_f32_32x32x16_f16 v[112:127], v[192:195], v[240:243], 0
    v_pk_fma_f16 v85, v97, v44, v85 op_sel:[0,1,0] op_sel_hi:[1,1,1]
    v_pk_fma_f16 v101, v81, v44, v101 op_sel:[0,1,0] op_sel_hi:[1,1,1] neg_lo:[1,0,0] neg_hi:[1,0,0]
    v_pk_mul_f16 v86, v82, v44 op_sel_hi:[1,0]
    v_pk_mul_f16 v102, v98, v44 op_sel_hi:[1,0]
    v_pk_fma_f16 v86, v98, v44, v86 op_sel:[0,1,0] op_sel_hi:[1,1,1]
    v_pk_fma_f16 v102, v82, v44, v102 op_sel:[0,1,0] op_sel_hi:[1,1,1] neg_lo:[1,0,0] neg_hi:[1,0,0]
    v_mfma_f32_32x32x16_f16 v[112:127], v[200:203], v[244:247], v[112:127]
    v_pk_mul_f16 v87, v83, v44 op_sel_hi:[1,0]
    v_pk_mul_f16 v103, v99, v44 op_sel_hi:[1,0]
    v_pk_fma_f16 v87, v99, v44, v87 op_sel:[0,1,0] op_sel_hi:[1,1,1]
    v_pk_fma_f16 v103, v83, v44, v103 op_sel:[0,1,0] op_sel_hi:[1,1,1] neg_lo:[1,0,0] neg_hi:[1,0,0]
    v_pk_mul_f16 v88, v80, v45 op_sel_hi:[1,0]
    v_pk_mul_f16 v104, v96, v45 op_sel_hi:[1,0]
    v_mfma_f32_32x32x16_f16 v[128:143], v[196:199], v[240:243], 0
    v_pk_fma_f16 v88, v96, v45, v88 op_sel:[0,1,0] op_sel_hi:[1,1,1]
    v_pk_fma_f16 v104, v80, v45, v104 op_sel:[0,1,0] op_sel_hi:[1,1,1] neg_lo:[1,0,0] neg_hi:[1,0,0]
    v_pk_mul_f16 v89, v81, v45 op_sel_hi:[1,0]
    v_pk_mul_f16 v105, v97, v45 op_sel_hi:[1,0]
    v_pk_fma_f16 v89, v97, v45, v89 op_sel:[0,1,0] op_sel_hi:[1,1,1]
    v_pk_fma_f16 v105, v81, v45, v105 op_sel:[0,1,0] op_sel_hi:[1,1,1] neg_lo:[1,0,0] neg_hi:[1,0,0]
    v_mfma_f32_32x32x16_f16 v[128:143], v[204:207], v[244:247], v[128:143]
    v_pk_mul_f16 v90, v82, v45 op_sel_hi:[1,0]
    v_pk_mul_f16 v106, v98, v45 op_sel_hi:[1,0]
    v_pk_fma_f16 v90, v98, v45, v90 op_sel:[0,1,0] op_sel_hi:[1,1,1]
    v_pk_fma_f16 v106, v82, v45, v106 op_sel:[0,1,0] op_sel_hi:[1,1,1] neg_lo:[1,0,0] neg_hi:[1,0,0]
    v_pk_mul_f16 v91, v83, v45 op_sel_hi:[1,0]
    v_pk_mul_f16 v107, v99, v45 op_sel_hi:[1,0]
    v_pk_fma_f16 v91, v99, v45, v91 op_sel:[0,1,0] op_sel_hi:[1,1,1]
    v_pk_fma_f16 v107, v83, v45, v107 op_sel:[0,1,0] op_sel_hi:[1,1,1] neg_lo:[1,0,0] neg_hi:[1,0,0]
    v_pk_mul_f16 v92, v84, v45 op_sel_hi:[1,0]
    v_pk_mul_f16 v108, v100, v45 op_sel_hi:[1,0]
    v_pk_fma_f16 v92, v100, v45, v92 op_sel:[0,1,0] op_sel_hi:[1,1,1]
    v_pk_fma_f16 v108, v84, v45, v108 op_sel:[0,1,0] op_sel_hi:[1,1,1] neg_lo:[1,0,0] neg_hi:[1,0,0]
    v_pk_mul_f16 v93, v85, v45 op_sel_hi:[1,0]
    v_pk_mul_f16 v109, v101, v45 op_sel_hi:[1,0]
    v_pk_fma_f16 v93, v101, v45, v93 op_sel:[0,1,0] op_sel_hi:[1,1,1]
    v_pk_fma_f16 v109, v85, v45, v109 op_sel:[0,1,0] op_sel_hi:[1,1,1] neg_lo:[1,0,0] neg_hi:[1,0,0]
    v_pk_mul_f16 v94, v86, v45 op_sel_hi:[1,0]
    v_pk_mul_f16 v110, v102, v45 op_sel_hi:[1,0]
    v_pk_fma_f16 v94, v102, v45, v94 op_sel:[0,1,0] op_sel_hi:[1,1,1]
    v_pk_fma_f16 v110, v86, v45, v110 op_sel:[0,1,0] op_sel_hi:[1,1,1] neg_lo:[1,0,0] neg_hi:[1,0,0]
    v_pk_mul_f16 v95, v87, v45 op_sel_hi:[1,0]
    v_pk_mul_f16 v111, v103, v45 op_sel_hi:[1,0]
    v_pk_fma_f16 v95, v103, v45, v95 op_sel:[0,1,0] op_sel_hi:[1,1,1]
    v_pk_fma_f16 v111, v87, v45, v111 op_sel:[0,1,0] op_sel_hi:[1,1,1] neg_lo:[1,0,0] neg_hi:[1,0,0]
    v_cvt_pk_f16_f32 v144, v208, v209
    v_cvt_pk_f16_f32 v145, v210, v211
    v_cvt_pk_f16_f32 v146, v212, v213
    v_cvt_pk_f16_f32 v147, v214, v215
    v_cvt_pk_f16_f32 v148, v216, v217
    v_cvt_pk_f16_f32 v149, v218, v219
    v_cvt_pk_f16_f32 v150, v220, v221
    v_cvt_pk_f16_f32 v151, v222, v223
    v_cvt_pk_f16_f32 v152, v224, v225
    v_cvt_pk_f16_f32 v153, v226, v227
    v_cvt_pk_f16_f32 v154, v228, v229
    v_cvt_pk_f16_f32 v155, v230, v231
    v_cvt_pk_f16_f32 v156, v232, v233
    v_cvt_pk_f16_f32 v157, v234, v235
    v_cvt_pk_f16_f32 v158, v236, v237
    v_cvt_pk_f16_f32 v159, v238, v239
    v_permlane32_swap_b32 v80, v84
    v_permlane32_swap_b32 v81, v85
    v_permlane32_swap_b32 v82, v86
    v_permlane32_swap_b32 v83, v87
    v_permlane32_swap_b32 v88, v92
    v_permlane32_swap_b32 v89, v93
    v_permlane32_swap_b32 v90, v94
    v_permlane32_swap_b32 v91, v95
    v_permlane32_swap_b32 v96, v100
    v_permlane32_swap_b32 v97, v101
    v_mfma_f32_32x32x16_f16 v[208:223], v[80:83], v[240:243], 0
    v_permlane32_swap_b32 v98, v102
    v_permlane32_swap_b32 v99, v103
    v_permlane32_swap_b32 v104, v108
    v_permlane32_swap_b32 v105, v109
    v_permlane32_swap_b32 v106, v110
    v_permlane32_swap_b32 v107, v111
    v_mfma_f32_32x32x16_f16 v[208:223], v[88:91], v[244:247], v[208:223]
    v_cvt_pk_f16_f32 v160, v112, v113
    v_cvt_pk_f16_f32 v161, v114, v115
    v_cvt_pk_f16_f32 v162, v116, v117
    v_cvt_pk_f16_f32 v163, v118, v119
    v_cvt_pk_f16_f32 v164, v120, v121
    v_cvt_pk_f16_f32 v165, v122, v123
    v_mfma_f32_32x32x16_f16 v[224:239], v[84:87], v[240:243], 0
    v_cvt_pk_f16_f32 v166, v124, v125
    v_cvt_pk_f16_f32 v167, v126, v127
    v_cvt_pk_f16_f32 v168, v128, v129
    v_cvt_pk_f16_f32 v169, v130, v131
    v_cvt_pk_f16_f32 v170, v132, v133
    v_cvt_pk_f16_f32 v171, v134, v135
    v_mfma_f32_32x32x16_f16 v[224:239], v[92:95], v[244:247], v[224:239]
    v_cvt_pk_f16_f32 v172, v136, v137
    v_cvt_pk_f16_f32 v173, v138, v139
    v_cvt_pk_f16_f32 v174, v140, v141
    v_cvt_pk_f16_f32 v175, v142, v143
    v_mfma_f32_32x32x16_f16 v[176:191], v[96:99], v[240:243], 0
    v_cvt_pk_f16_f32 v112, v208, v209
    v_cvt_pk_f16_f32 v113, v210, v211
    v_cvt_pk_f16_f32 v114, v212, v213
    v_cvt_pk_f16_f32 v115, v214, v215
    v_mfma_f32_32x32x16_f16 v[176:191], v[104:107], v[244:247], v[176:191]
    v_cvt_pk_f16_f32 v116, v216, v217
    v_cvt_pk_f16_f32 v117, v218, v219
    v_cvt_pk_f16_f32 v118, v220, v221
    v_cvt_pk_f16_f32 v119, v222, v223
    v_mfma_f32_32x32x16_f16 v[192:207], v[100:103], v[240:243], 0
    v_cvt_pk_f16_f32 v120, v224, v225
    v_cvt_pk_f16_f32 v121, v226, v227
    v_cvt_pk_f16_f32 v122, v228, v229
    v_cvt_pk_f16_f32 v123, v230, v231
    v_mfma_f32_32x32x16_f16 v[192:207], v[108:111], v[244:247], v[192:207]
    v_cvt_pk_f16_f32 v124, v232, v233
    v_cvt_pk_f16_f32 v125, v234, v235
    v_cvt_pk_f16_f32 v126, v236, v237
    v_cvt_pk_f16_f32 v127, v238, v239
    v_mfma_f32_32x32x16_f16 v[64:79], v[144:147], v[112:115], v[64:79]
    v_cvt_pk_f16_f32 v128, v176, v177
    v_cvt_pk_f16_f32 v129, v178, v179
    v_cvt_pk_f16_f32 v130, v180, v181
    v_cvt_pk_f16_f32 v131, v182, v183
    v_mfma_f32_32x32x16_f16 v[64:79], v[148:151], v[116:119], v[64:79]
    v_cvt_pk_f16_f32 v132, v184, v185
    v_cvt_pk_f16_f32 v133, v186, v187
    v_cvt_pk_f16_f32 v134, v188, v189
    v_cvt_pk_f16_f32 v135, v190, v191
    v_mfma_f32_32x32x16_f16 v[64:79], v[152:155], v[120:123], v[64:79]
    v_cvt_pk_f16_f32 v136, v192, v193
    v_cvt_pk_f16_f32 v137, v194, v195
    v_cvt_pk_f16_f32 v138, v196, v197
    v_cvt_pk_f16_f32 v139, v198, v199
    v_mfma_f32_32x32x16_f16 v[64:79], v[156:159], v[124:127], v[64:79]
    v_cvt_pk_f16_f32 v140, v200, v201
    v_cvt_pk_f16_f32 v141, v202, v203
    v_cvt_pk_f16_f32 v142, v204, v205
    v_cvt_pk_f16_f32 v143, v206, v207
    s_cmp_eq_u32 s84, 0
    s_cbranch_scc1 L_sr20
    s_load_dwordx16 s[4:19], s[36:37], s81 glc
    s_add_u32 s75, s81, 64
    s_load_dwordx16 s[20:35], s[36:37], s75 glc
    s_add_u32 s75, s81, 163840
    s_load_dword s98, s[36:37], s75 glc
L_sr20:
    v_mfma_f32_32x32x16_f16 v[64:79], v[160:163], v[128:131], v[64:79]
    v_mfma_f32_32x32x16_f16 v[64:79], v[164:167], v[132:135], v[64:79]
    v_mfma_f32_32x32x16_f16 v[64:79], v[168:171], v[136:139], v[64:79]
    v_mfma_f32_32x32x16_f16 v[64:79], v[172:175], v[140:143], v[64:79]
    s_cmp_eq_u32 s84, 1
    s_cbranch_scc1 L_kdone
    s_mov_b32 s84, 1
    s_waitcnt vmcnt(0)
    s_barrier
    ds_read_b64_tr_b16 v[208:209], v248 offset:0
    ds_read_b64_tr_b16 v[210:211], v248 offset:512
    ds_read_b64_tr_b16 v[212:213], v248 offset:4096
    ds_read_b64_tr_b16 v[214:215], v248 offset:4608
    s_waitcnt lgkmcnt(0)
    ds_write_b128 v249, v[208:211] offset:0
    ds_write_b128 v249, v[212:215] offset:64
    ds_read_b128 v[24:27], v250 offset:0
    ds_read_b128 v[28:31], v250 offset:1152
    s_waitcnt lgkmcnt(0)
    buffer_store_dwordx4 v[24:27], v251, s[52:55], s85 offen sc1
    buffer_store_dwordx4 v[28:31], v251, s[52:55], s83 offen sc1
    s_setprio 0
    s_branch L_kround
L_kdone:
    s_setprio 0
    s_setprio 2
    s_mov_b32 s86, 0
L_pt21:
    s_waitcnt lgkmcnt(0)
    s_cmp_eq_u64 s[4:5], s[88:89]
    s_cbranch_scc0 L_pb22
    s_cmp_eq_u64 s[6:7], s[88:89]
    s_cbranch_scc0 L_pb22
    s_cmp_eq_u64 s[8:9], s[88:89]
    s_cbranch_scc0 L_pb22
    s_cmp_eq_u64 s[10:11], s[88:89]
    s_cbranch_scc0 L_pb22
    s_cmp_eq_u64 s[12:13], s[88:89]
    s_cbranch_scc0 L_pb22
    s_cmp_eq_u64 s[14:15], s[88:89]
    s_cbranch_scc0 L_pb22
    s_cmp_eq_u64 s[16:17], s[88:89]
    s_cbranch_scc0 L_pb22
    s_cmp_eq_u64 s[18:19], s[88:89]
    s_cbranch_scc0 L_pb22
    s_cmp_eq_u64 s[20:21], s[88:89]
    s_cbranch_scc0 L_pb22
    s_cmp_eq_u64 s[22:23], s[88:89]
    s_cbranch_scc0 L_pb22
    s_cmp_eq_u64 s[24:25], s[88:89]
    s_cbranch_scc0 L_pb22
    s_cmp_eq_u64 s[26:27], s[88:89]
    s_cbranch_scc0 L_pb22
    s_cmp_eq_u64 s[28:29], s[88:89]
    s_cbranch_scc0 L_pb22
    s_cmp_eq_u64 s[30:31], s[88:89]
    s_cbranch_scc0 L_pb22
    s_cmp_eq_u64 s[32:33], s[88:89]
    s_cbranch_scc0 L_pb22
    s_cmp_eq_u64 s[34:35], s[88:89]
    s_cbranch_scc0 L_pb22
    s_cmp_eq_u32 s98, s63
    s_cbranch_scc0 L_pb22
    s_branch L_po23
L_pb22:
    s_add_u32 s86, s86, 1
    s_cmp_ge_u32 s86, 20000
    s_cbranch_scc1 L_po23
    s_sleep 2
    s_load_dwordx16 s[4:19], s[36:37], s81 glc
    s_add_u32 s75, s81, 64
    s_load_dwordx16 s[20:35], s[36:37], s75 glc
    s_add_u32 s75, s81, 163840
    s_load_dword s98, s[36:37], s75 glc
    s_branch L_pt21
L_po23:
    s_mul_i32 s74, s78, 4224
    s_lshl_b32 s72, s62, 11
    s_add_u32 s74, s74, s72
    s_add_u32 s74, s74, 1048576
    buffer_load_dwordx4 v[176:179], v4, s[52:55], s74 offen offset:0 sc1
    buffer_load_dwordx4 v[180:183], v4, s[52:55], s74 offen offset:1024 sc1
    s_cmp_eq_u32 s62, 0
    s_cselect_b32 s72, 2.0, 0
    v_mov_b32 v40, 2.0
    v_writelane_b32 v40, s72, 0
    s_sub_u32 s75, s74, 8
    buffer_load_dwordx2 v[184:185], v40, s[52:55], s75 offen sc1
    v_and_b32 v16, 31, v0
    v_lshlrev_b32 v16, 4, v16
    v_add_u32 v16, s80, v16
    v_lshrrev_b32 v17, 5, v0
    v_lshl_add_u32 v18, v17, 3, v16
    v_lshl_add_u32 v19, v17, 9, v16
    v_lshl_add_u32 v16, v17, 10, v16
    v_and_b32 v17, 1, v0
    v_cmp_eq_u32 vcc, 1, v17
    s_nop 7
    v_mul_f32 v64, s97, v64
    v_mul_f32 v65, s97, v65
    v_mul_f32 v66, s97, v66
    v_mul_f32 v67, s97, v67
    v_mul_f32 v68, s97, v68
    v_mul_f32 v69, s97, v69
    v_mul_f32 v70, s97, v70
    v_mul_f32 v71, s97, v71
    v_mul_f32 v72, s97, v72
    v_mul_f32 v73, s97, v73
    v_mul_f32 v74, s97, v74
    v_mul_f32 v75, s97, v75
    v_mul_f32 v76, s97, v76
    v_mul_f32 v77, s97, v77
    v_mul_f32 v78, s97, v78
    v_mul_f32 v79, s97, v79
    s_and_b32 s93, s93, 0x7fffffff
    s_cbranch_scc0 L_stable
    v_and_b32 v44, 31, v0
    v_lshlrev_b32 v44, 3, v44
    v_lshrrev_b32 v45, 5, v0
    v_lshl_add_u32 v46, v45, 2, v44
    v_add_u32 v47, 0, v46
    v_cvt_f32_u32 v47, v47
    v_mul_f32 v47, v62, v47
    v_exp_f32 v47, v47
    s_nop 0
    v_mul_f32 v64, v64, v47
    v_add_u32 v47, 2, v46
    v_cvt_f32_u32 v47, v47
    v_mul_f32 v47, v62, v47
    v_exp_f32 v47, v47
    s_nop 0
    v_mul_f32 v65, v65, v47
    v_add_u32 v47, 1, v46
    v_cvt_f32_u32 v47, v47
    v_mul_f32 v47, v62, v47
    v_exp_f32 v47, v47
    s_nop 0
    v_mul_f32 v66, v66, v47
    v_add_u32 v47, 3, v46
    v_cvt_f32_u32 v47, v47
    v_mul_f32 v47, v62, v47
    v_exp_f32 v47, v47
    s_nop 0
    v_mul_f32_e64 v67, v67, v47
    v_lshl_add_u32 v46, v45, 2, v44
    v_add_u32 v47, 256, v46
    v_cvt_f32_u32 v47, v47
    v_mul_f32 v47, v62, v47
    v_exp_f32 v47, v47
    s_nop 0
    v_mul_f32 v68, v68, v47
    v_add_u32 v47, 258, v46
    v_cvt_f32_u32 v47, v47
    v_mul_f32 v47, v62, v47
    v_exp_f32 v47, v47
    s_nop 0
    v_mul_f32 v69, v69, v47
    v_add_u32 v47, 0, v46
    v_cvt_f32_u32 v47, v47
    v_mul_f32 v47, v62, v47
    v_exp_f32 v47, v47
    s_nop 0
    v_mul_f32 v70, v70, v47
    v_add_u32 v47, 260, v46
    v_cvt_f32_u32 v47, v47
    v_mul_f32 v47, v62, v47
    v_exp_f32 v47, v47
    s_nop 0
    v_mul_f32_e64 v71, v71, v47
    v_lshl_add_u32 v46, v45, 8, v44
    v_add_u32 v47, 512, v46
    v_cvt_f32_u32 v47, v47
    v_mul_f32 v47, v62, v47
    v_exp_f32 v47, v47
    s_nop 0
    v_mul_f32 v72, v72, v47
    v_add_u32 v47, 520, v46
    v_cvt_f32_u32 v47, v47
    v_mul_f32 v47, v62, v47
    v_exp_f32 v47, v47
    s_nop 0
    v_mul_f32 v73, v73, v47
    v_add_u32 v47, 516, v46
    v_cvt_f32_u32 v47, v47
    v_mul_f32 v47, v62, v47
    v_exp_f32 v47, v47
    s_nop 0
    v_mul_f32 v74, v74, v47
    v_add_u32 v47, 0, v46
    v_cvt_f32_u32 v47, v47
    v_mul_f32 v47, v62, v47
    v_exp_f32 v47, v47
    s_nop 0
    v_mul_f32_e64 v75, v75, v47
    v_lshl_add_u32 v46, v45, 9, v44
    v_add_u32 v47, 1024, v46
    v_cvt_f32_u32 v47, v47
    v_mul_f32 v47, v62, v47
    v_exp_f32 v47, v47
    s_nop 0
    v_mul_f32 v76, v76, v47
    v_add_u32 v47, 1032, v46
    v_cvt_f32_u32 v47, v47
    v_mul_f32 v47, v62, v47
    v_exp_f32 v47, v47
    s_nop 0
    v_mul_f32 v77, v77, v47
    v_add_u32 v47, 1280, v46
    v_cvt_f32_u32 v47, v47
    v_mul_f32 v47, v62, v47
    v_exp_f32 v47, v47
    s_nop 0
    v_mul_f32 v78, v78, v47
    v_add_u32 v47, 1288, v46
    v_cvt_f32_u32 v47, v47
    v_mul_f32 v47, v62, v47
    v_exp_f32 v47, v47
    s_nop 0
    v_mul_f32 v79, v79, v47
L_stable:
    s_cmp_eq_u32 s62, 0
    s_cbranch_scc1 L_even0
    ds_write_b128 v8, v[64:67] offset:0
    ds_write_b128 v8, v[68:71] offset:1024
    v_lshlrev_b32 v56, 3, v0
    v_add_u32 v56, s80, v56
    v_mov_b32 v58, 0
    v_mov_b32 v59, 0
    ds_write_b64 v56, v[58:59]
    v_mov_b32 v32, v72
    v_mov_b32 v33, v73
    v_mov_b32 v34, v74
    v_mov_b32 v35, v75
    v_mov_b32 v36, v76
    v_mov_b32 v37, v77
    v_mov_b32_e64 v38, v78
    v_mov_b32 v39, v79
    s_branch L_join0
L_even0:
    ds_write_b128 v8, v[72:75] offset:0
    ds_write_b128 v8, v[76:79] offset:1024
    v_lshrrev_b32 v56, 4, v0
    v_mul_u32_u24 v56, 4160, v56
    v_and_b32 v57, 15, v0
    v_lshl_add_u32 v56, v57, 2, v56
    v_add_u32 v56, s79, v56
    v_mov_b32 v57, 0
    ds_write_b32 v56, v57
    v_mov_b32 v32, v64
    v_mov_b32 v33, v65
    v_mov_b32 v34, v66
    v_mov_b32 v35, v67
    v_mov_b32 v36, v68
    v_mov_b32 v37, v69
    v_mov_b32 v38, v70
    v_mov_b32 v39, v71
L_join0:
    s_waitcnt lgkmcnt(0)
    s_barrier
    ds_read_b128 v[24:27], v9 offset:0
    ds_read_b128 v[28:31], v9 offset:1024
    s_waitcnt lgkmcnt(0)
    v_add_f32 v24, v24, v32
    v_add_f32 v25, v25, v33
    v_add_f32 v26, v26, v34
    v_add_f32 v27, v27, v35
    v_add_f32 v28, v28, v36
    v_add_f32 v29, v29, v37
    v_add_f32 v30, v30, v38
    v_add_f32_e64 v31, v31, v39
    s_cmp_eq_u32 s62, 0
    s_cbranch_scc1 L_even1
    v_cvt_pk_bf16_f32 v60, v24, v24
    v_cvt_pk_bf16_f32 v61, v24, v26
    v_cvt_pk_bf16_f32 v62, v26, v26
    v_cvt_pk_bf16_f32 v63, v25, v25
    ds_write_b128 v19, v[60:63] offset:1536
    v_cndmask_b32 v17, v28, v29, vcc
    v_cvt_pk_bf16_f32 v64, v28, v28
    v_cvt_pk_bf16_f32 v66, v17, v29
    v_cvt_pk_bf16_f32 v67, v29, v29
    v_mov_b32 v65, v64
    ds_write_b128 v16, v[64:67] offset:2560
    v_cndmask_b32 v17, v30, v31, vcc
    v_cvt_pk_bf16_f32 v68, v30, v30
    v_cvt_pk_bf16_f32 v70, v17, v31
    v_cvt_pk_bf16_f32 v71, v31, v31
    v_mov_b32 v69, v68
    ds_write_b128 v16, v[68:71] offset:3072
    s_branch L_join1
L_even1:
    v_cvt_pk_bf16_f32 v60, v24, v26
    v_cvt_pk_bf16_f32 v61, v25, v27
    v_cvt_pk_bf16_f32 v62, v28, v28
    v_cvt_pk_bf16_f32 v63, v29, v31
    ds_write_b64 v18, v[60:61] offset:512
    ds_write_b64 v18, v[62:63] offset:1024
L_join1:
    v_mov_b32 v42, 0xb73621
    s_waitcnt vmcnt(0)
    v_readlane_b32 s72, v178, 63
    v_readlane_b32 s73, v179, 63
    v_mov_b32 v188, v185
    v_mov_b32 v186, s72
    v_mov_b32_e64 v192, s73
    ds_write_b128 v10, v[176:179] offset:32
    v_mov_b32_dpp v188, v179 wave_shr:1 row_mask:0xf bank_mask:0xf
    v_mov_b32_dpp v184, v178 wave_shr:1 row_mask:0xf bank_mask:0xf
    v_mov_b32 v189, v176
    v_mov_b32 v190, v177
    v_mov_b32_e64 v191, v178
    ds_write_b128 v10, v[188:191] offset:8352
    v_alignbit_b32 v196, v176, v188, 16
    v_alignbit_b32 v197, v177, v189, 16
    v_alignbit_b32 v198, v178, v190, 16
    v_alignbit_b32 v199, v179, v191, 16
    ds_write_b128 v10, v[196:199] offset:4192
    v_alignbit_b32 v204, v188, v184, 16
    v_mov_b32 v205, v196
    v_mov_b32 v206, v197
    v_mov_b32_e64 v207, v198
    ds_write_b128 v10, v[204:207] offset:12512
    ds_write_b128 v10, v[180:183] offset:1056
    v_mov_b32_dpp v192, v183 wave_shr:1 row_mask:0xf bank_mask:0xf
    v_mov_b32_dpp v186, v182 wave_shr:1 row_mask:0xf bank_mask:0xf
    v_mov_b32 v193, v180
    v_mov_b32 v194, v181
    v_mov_b32_e64 v195, v182
    ds_write_b128 v10, v[192:195] offset:9376
    v_alignbit_b32 v200, v180, v192, 16
    v_alignbit_b32 v201, v181, v193, 16
    v_alignbit_b32 v202, v182, v194, 16
    v_alignbit_b32 v203, v183, v195, 16
    ds_write_b128 v10, v[200:203] offset:5216
    v_alignbit_b32 v208, v192, v186, 16
    v_mov_b32 v209, v200
    v_mov_b32 v210, v201
    v_mov_b32 v211, v202
    ds_write_b128 v10, v[208:211] offset:13536
    s_waitcnt lgkmcnt(0)
    s_barrier
    s_setprio 0
    ds_read_b64_tr_b16 v[64:65], v6 offset:8
    ds_read_b64_tr_b16 v[66:67], v6 offset:0
    ds_read_b128 v[96:99], v7 offset:192
    ds_read_b64_tr_b16 v[68:69], v6 offset:520
    ds_read_b64_tr_b16 v[70:71], v6 offset:512
    ds_read_b128 v[100:103], v7 offset:704
    ds_read_b64_tr_b16 v[72:73], v6 offset:1032
    ds_read_b64_tr_b16 v[74:75], v6 offset:1024
    ds_read_b128 v[104:107], v7 offset:1216
    ds_read_b64_tr_b16 v[76:77], v6 offset:1544
    ds_read_b64_tr_b16 v[78:79], v6 offset:1536
    ds_read_b128 v[108:111], v7 offset:1728
    ds_read_b64_tr_b16 v[80:81], v6 offset:2056
    ds_read_b64_tr_b16 v[82:83], v6 offset:2048
    ds_read_b128 v[112:115], v7 offset:2240
    ds_read_b64_tr_b16 v[84:85], v6 offset:2568
    ds_read_b64_tr_b16 v[86:87], v6 offset:2560
    ds_read_b128 v[116:119], v7 offset:2752
    ds_read_b64_tr_b16 v[88:89], v6 offset:3080
    ds_read_b64_tr_b16 v[90:91], v6 offset:3072
    ds_read_b128 v[120:123], v7 offset:3264
    ds_read_b64_tr_b16 v[92:93], v6 offset:3592
    ds_read_b64_tr_b16 v[94:95], v6 offset:3584
    ds_read_b128 v[124:127], v7 offset:3776
    s_add_u32 s74, s81, 163844
    s_mov_b32 s86, 0
L_go:
    s_load_dword s98, s[36:37], s74 glc
    s_waitcnt lgkmcnt(0)
    s_cmp_eq_u32 s98, s63
    s_cbranch_scc1 L_go_ok
    s_sleep 2
    s_add_u32 s86, s86, 1
    s_cmp_lt_u32 s86, 64
    s_cbranch_scc1 L_go
L_go_ok:
    s_mul_i32 s74, s78, 4224
    s_lshl_b32 s72, s62, 11
    s_add_u32 s74, s74, s72
    s_add_u32 s74, s74, 3145728
    s_waitcnt lgkmcnt(0)
    v_mfma_f32_16x16x32_bf16 v[20:23], v[64:67], v[96:99], 0
    ds_read_b64_tr_b16 v[128:129], v6 offset:72
    v_mfma_f32_16x16x32_bf16 v[24:27], v[64:67], v[100:103], 0
    ds_read_b64_tr_b16 v[130:131], v6 offset:64
    v_mfma_f32_16x16x32_bf16 v[28:31], v[64:67], v[104:107], 0
    ds_read_b128 v[160:163], v7 offset:128
    v_mfma_f32_16x16x32_bf16 v[32:35], v[64:67], v[108:111], 0
    ds_read_b64_tr_b16 v[132:133], v6 offset:584
    v_mfma_f32_16x16x32_bf16 v[36:39], v[64:67], v[112:115], 0
    ds_read_b64_tr_b16 v[134:135], v6 offset:576
    v_mfma_f32_16x16x32_bf16 v[40:43], v[64:67], v[116:119], 0
    ds_read_b128 v[164:167], v7 offset:640
    v_mfma_f32_16x16x32_bf16 v[44:47], v[64:67], v[120:123], 0
    ds_read_b64_tr_b16 v[136:137], v6 offset:1096
    v_mfma_f32_16x16x32_bf16 v[48:51], v[64:67], v[124:127], 0
    ds_read_b64_tr_b16 v[138:139], v6 offset:1088
    v_mfma_f32_16x16x32_bf16 v[24:27], v[68:71], v[96:99], v[24:27]
    ds_read_b128 v[168:171], v7 offset:1152
    v_mfma_f32_16x16x32_bf16 v[28:31], v[68:71], v[100:103], v[28:31]
    ds_read_b64_tr_b16 v[140:141], v6 offset:1608
    v_mfma_f32_16x16x32_bf16 v[32:35], v[68:71], v[104:107], v[32:35]
    ds_read_b64_tr_b16 v[142:143], v6 offset:1600
    v_mfma_f32_16x16x32_bf16 v[36:39], v[68:71], v[108:111], v[36:39]
    ds_read_b128 v[172:175], v7 offset:1664
    v_mfma_f32_16x16x32_bf16 v[40:43], v[68:71], v[112:115], v[40:43]
    ds_read_b64_tr_b16 v[144:145], v6 offset:2120
    v_mfma_f32_16x16x32_bf16 v[44:47], v[68:71], v[116:119], v[44:47]
    ds_read_b64_tr_b16 v[146:147], v6 offset:2112
    v_mfma_f32_16x16x32_bf16 v[48:51], v[68:71], v[120:123], v[48:51]
    ds_read_b128 v[176:179], v7 offset:2176
    v_mfma_f32_16x16x32_bf16 v[28:31], v[72:75], v[96:99], v[28:31]
    ds_read_b64_tr_b16 v[148:149], v6 offset:2632
    v_mfma_f32_16x16x32_bf16 v[32:35], v[72:75], v[100:103], v[32:35]
    ds_read_b64_tr_b16 v[150:151], v6 offset:2624
    v_mfma_f32_16x16x32_bf16 v[36:39], v[72:75], v[104:107], v[36:39]
    ds_read_b128 v[180:183], v7 offset:2688
    v_mfma_f32_16x16x32_bf16 v[40:43], v[72:75], v[108:111], v[40:43]
    ds_read_b64_tr_b16 v[152:153], v6 offset:3144
    v_mfma_f32_16x16x32_bf16 v[44:47], v[72:75], v[112:115], v[44:47]
    ds_read_b64_tr_b16 v[154:155], v6 offset:3136
    v_mfma_f32_16x16x32_bf16 v[48:51], v[72:75], v[116:119], v[48:51]
    ds_read_b128 v[184:187], v7 offset:3200
    v_mfma_f32_16x16x32_bf16 v[32:35], v[76:79], v[96:99], v[32:35]
    ds_read_b64_tr_b16 v[156:157], v6 offset:3656
    v_mfma_f32_16x16x32_bf16 v[36:39], v[76:79], v[100:103], v[36:39]
    ds_read_b64_tr_b16 v[158:159], v6 offset:3648
    v_mfma_f32_16x16x32_bf16 v[40:43], v[76:79], v[104:107], v[40:43]
    ds_read_b128 v[188:191], v7 offset:3712
    v_mfma_f32_16x16x32_bf16 v[44:47], v[76:79], v[108:111], v[44:47]
    v_mfma_f32_16x16x32_bf16 v[48:51], v[76:79], v[112:115], v[48:51]
    v_mfma_f32_16x16x32_bf16 v[36:39], v[80:83], v[96:99], v[36:39]
    v_mfma_f32_16x16x32_bf16 v[40:43], v[80:83], v[100:103], v[40:43]
    v_mfma_f32_16x16x32_bf16 v[44:47], v[80:83], v[104:107], v[44:47]
    v_mfma_f32_16x16x32_bf16 v[48:51], v[80:83], v[108:111], v[48:51]
    v_mfma_f32_16x16x32_bf16 v[40:43], v[84:87], v[96:99], v[40:43]
    v_mfma_f32_16x16x32_bf16 v[44:47], v[84:87], v[100:103], v[44:47]
    v_mfma_f32_16x16x32_bf16 v[48:51], v[84:87], v[104:107], v[48:51]
    v_mfma_f32_16x16x32_bf16 v[44:47], v[88:91], v[96:99], v[44:47]
    v_mfma_f32_16x16x32_bf16 v[48:51], v[88:91], v[100:103], v[48:51]
    v_mfma_f32_16x16x32_bf16 v[48:51], v[92:95], v[96:99], v[48:51]
    s_waitcnt lgkmcnt(0)
    v_mfma_f32_16x16x32_bf16 v[20:23], v[128:131], v[160:163], v[20:23]
    ds_read_b64_tr_b16 v[64:65], v6 offset:136
    v_mfma_f32_16x16x32_bf16 v[24:27], v[128:131], v[164:167], v[24:27]
    ds_read_b64_tr_b16 v[66:67], v6 offset:128
    v_mfma_f32_16x16x32_bf16 v[28:31], v[128:131], v[168:171], v[28:31]
    ds_read_b128 v[96:99], v7 offset:64
    v_mfma_f32_16x16x32_bf16 v[32:35], v[128:131], v[172:175], v[32:35]
    ds_read_b64_tr_b16 v[68:69], v6 offset:648
    v_mfma_f32_16x16x32_bf16 v[36:39], v[128:131], v[176:179], v[36:39]
    ds_read_b64_tr_b16 v[70:71], v6 offset:640
    v_mfma_f32_16x16x32_bf16 v[40:43], v[128:131], v[180:183], v[40:43]
    ds_read_b128 v[100:103], v7 offset:576
    v_mfma_f32_16x16x32_bf16 v[44:47], v[128:131], v[184:187], v[44:47]
    ds_read_b64_tr_b16 v[72:73], v6 offset:1160
    v_mfma_f32_16x16x32_bf16 v[48:51], v[128:131], v[188:191], v[48:51]
    ds_read_b64_tr_b16 v[74:75], v6 offset:1152
    v_mfma_f32_16x16x32_bf16 v[24:27], v[132:135], v[160:163], v[24:27]
    ds_read_b128 v[104:107], v7 offset:1088
    v_mfma_f32_16x16x32_bf16 v[28:31], v[132:135], v[164:167], v[28:31]
    ds_read_b64_tr_b16 v[76:77], v6 offset:1672
    v_mfma_f32_16x16x32_bf16 v[32:35], v[132:135], v[168:171], v[32:35]
    ds_read_b64_tr_b16 v[78:79], v6 offset:1664
    v_mfma_f32_16x16x32_bf16 v[36:39], v[132:135], v[172:175], v[36:39]
    ds_read_b128 v[108:111], v7 offset:1600
    v_mfma_f32_16x16x32_bf16 v[40:43], v[132:135], v[176:179], v[40:43]
    ds_read_b64_tr_b16 v[80:81], v6 offset:2184
    v_mfma_f32_16x16x32_bf16 v[44:47], v[132:135], v[180:183], v[44:47]
    ds_read_b64_tr_b16 v[82:83], v6 offset:2176
    v_mfma_f32_16x16x32_bf16 v[48:51], v[132:135], v[184:187], v[48:51]
    ds_read_b128 v[112:115], v7 offset:2112
    v_mfma_f32_16x16x32_bf16 v[28:31], v[136:139], v[160:163], v[28:31]
    ds_read_b64_tr_b16 v[84:85], v6 offset:2696
    v_mfma_f32_16x16x32_bf16 v[32:35], v[136:139], v[164:167], v[32:35]
    ds_read_b64_tr_b16 v[86:87], v6 offset:2688
    v_mfma_f32_16x16x32_bf16 v[36:39], v[136:139], v[168:171], v[36:39]
    ds_read_b128 v[116:119], v7 offset:2624
    v_mfma_f32_16x16x32_bf16 v[40:43], v[136:139], v[172:175], v[40:43]
    ds_read_b64_tr_b16 v[88:89], v6 offset:3208
    v_mfma_f32_16x16x32_bf16 v[44:47], v[136:139], v[176:179], v[44:47]
    ds_read_b64_tr_b16 v[90:91], v6 offset:3200
    v_mfma_f32_16x16x32_bf16 v[48:51], v[136:139], v[180:183], v[48:51]
    ds_read_b128 v[120:123], v7 offset:3136
    v_mfma_f32_16x16x32_bf16 v[32:35], v[140:143], v[160:163], v[32:35]
    ds_read_b64_tr_b16 v[92:93], v6 offset:3720
    v_mfma_f32_16x16x32_bf16 v[36:39], v[140:143], v[164:167], v[36:39]
    ds_read_b64_tr_b16 v[94:95], v6 offset:3712
    v_mfma_f32_16x16x32_bf16 v[40:43], v[140:143], v[168:171], v[40:43]
    ds_read_b128 v[124:127], v7 offset:3648
    v_mfma_f32_16x16x32_bf16 v[44:47], v[140:143], v[172:175], v[44:47]
    v_mfma_f32_16x16x32_bf16 v[48:51], v[140:143], v[176:179], v[48:51]
    v_mfma_f32_16x16x32_bf16 v[36:39], v[144:147], v[160:163], v[36:39]
    v_mfma_f32_16x16x32_bf16 v[40:43], v[144:147], v[164:167], v[40:43]
    v_mfma_f32_16x16x32_bf16 v[44:47], v[144:147], v[168:171], v[44:47]
    v_mfma_f32_16x16x32_bf16 v[48:51], v[144:147], v[172:175], v[48:51]
    v_mfma_f32_16x16x32_bf16 v[40:43], v[148:151], v[160:163], v[40:43]
    v_mfma_f32_16x16x32_bf16 v[44:47], v[148:151], v[164:167], v[44:47]
    v_mfma_f32_16x16x32_bf16 v[48:51], v[148:151], v[168:171], v[48:51]
    v_mfma_f32_16x16x32_bf16 v[44:47], v[152:155], v[160:163], v[44:47]
    v_mfma_f32_16x16x32_bf16 v[48:51], v[152:155], v[164:167], v[48:51]
    v_mfma_f32_16x16x32_bf16 v[48:51], v[156:159], v[160:163], v[48:51]
    s_waitcnt lgkmcnt(0)
    v_mfma_f32_16x16x32_bf16 v[20:23], v[64:67], v[96:99], v[20:23]
    ds_read_b64_tr_b16 v[128:129], v6 offset:200
    v_mfma_f32_16x16x32_bf16 v[24:27], v[64:67], v[100:103], v[24:27]
    ds_read_b64_tr_b16 v[130:131], v6 offset:192
    v_mfma_f32_16x16x32_bf16 v[28:31], v[64:67], v[104:107], v[28:31]
    ds_read_b128 v[160:163], v7 offset:0
    v_mfma_f32_16x16x32_bf16 v[32:35], v[64:67], v[108:111], v[32:35]
    ds_read_b64_tr_b16 v[132:133], v6 offset:712
    v_mfma_f32_16x16x32_bf16 v[36:39], v[64:67], v[112:115], v[36:39]
    ds_read_b64_tr_b16 v[134:135], v6 offset:704
    v_mfma_f32_16x16x32_bf16 v[40:43], v[64:67], v[116:119], v[40:43]
    ds_read_b128 v[164:167], v7 offset:512
    v_mfma_f32_16x16x32_bf16 v[44:47], v[64:67], v[120:123], v[44:47]
    ds_read_b64_tr_b16 v[136:137], v6 offset:1224
    v_mfma_f32_16x16x32_bf16 v[48:51], v[64:67], v[124:127], v[48:51]
    ds_read_b64_tr_b16 v[138:139], v6 offset:1216
    v_mfma_f32_16x16x32_bf16 v[24:27], v[68:71], v[96:99], v[24:27]
    ds_read_b128 v[168:171], v7 offset:1024
    v_mfma_f32_16x16x32_bf16 v[28:31], v[68:71], v[100:103], v[28:31]
    ds_read_b64_tr_b16 v[140:141], v6 offset:1736
    v_mfma_f32_16x16x32_bf16 v[32:35], v[68:71], v[104:107], v[32:35]
    ds_read_b64_tr_b16 v[142:143], v6 offset:1728
    v_mfma_f32_16x16x32_bf16 v[36:39], v[68:71], v[108:111], v[36:39]
    ds_read_b128 v[172:175], v7 offset:1536
    v_mfma_f32_16x16x32_bf16 v[40:43], v[68:71], v[112:115], v[40:43]
    ds_read_b64_tr_b16 v[144:145], v6 offset:2248
    v_mfma_f32_16x16x32_bf16 v[44:47], v[68:71], v[116:119], v[44:47]
    ds_read_b64_tr_b16 v[146:147], v6 offset:2240
    v_mfma_f32_16x16x32_bf16 v[48:51], v[68:71], v[120:123], v[48:51]
    ds_read_b128 v[176:179], v7 offset:2048
    v_mfma_f32_16x16x32_bf16 v[28:31], v[72:75], v[96:99], v[28:31]
    ds_read_b64_tr_b16 v[148:149], v6 offset:2760
    v_mfma_f32_16x16x32_bf16 v[32:35], v[72:75], v[100:103], v[32:35]
    ds_read_b64_tr_b16 v[150:151], v6 offset:2752
    v_mfma_f32_16x16x32_bf16 v[36:39], v[72:75], v[104:107], v[36:39]
    ds_read_b128 v[180:183], v7 offset:2560
    v_mfma_f32_16x16x32_bf16 v[40:43], v[72:75], v[108:111], v[40:43]
    ds_read_b64_tr_b16 v[152:153], v6 offset:3272
    v_mfma_f32_16x16x32_bf16 v[44:47], v[72:75], v[112:115], v[44:47]
    ds_read_b64_tr_b16 v[154:155], v6 offset:3264
    v_mfma_f32_16x16x32_bf16 v[48:51], v[72:75], v[116:119], v[48:51]
    ds_read_b128 v[184:187], v7 offset:3072
    v_mfma_f32_16x16x32_bf16 v[32:35], v[76:79], v[96:99], v[32:35]
    ds_read_b64_tr_b16 v[156:157], v6 offset:3784
    v_mfma_f32_16x16x32_bf16 v[36:39], v[76:79], v[100:103], v[36:39]
    ds_read_b64_tr_b16 v[158:159], v6 offset:3776
    v_mfma_f32_16x16x32_bf16 v[40:43], v[76:79], v[104:107], v[40:43]
    ds_read_b128 v[188:191], v7 offset:3584
    v_mfma_f32_16x16x32_bf16 v[44:47], v[76:79], v[108:111], v[44:47]
    v_mfma_f32_16x16x32_bf16 v[48:51], v[76:79], v[112:115], v[48:51]
    v_mfma_f32_16x16x32_bf16 v[36:39], v[80:83], v[96:99], v[36:39]
    v_mfma_f32_16x16x32_bf16 v[40:43], v[80:83], v[100:103], v[40:43]
    v_mfma_f32_16x16x32_bf16 v[44:47], v[80:83], v[104:107], v[44:47]
    v_mfma_f32_16x16x32_bf16 v[48:51], v[80:83], v[108:111], v[48:51]
    v_mfma_f32_16x16x32_bf16 v[40:43], v[84:87], v[96:99], v[40:43]
    v_mfma_f32_16x16x32_bf16 v[44:47], v[84:87], v[100:103], v[44:47]
    v_mfma_f32_16x16x32_bf16 v[48:51], v[84:87], v[104:107], v[48:51]
    v_mfma_f32_16x16x32_bf16 v[44:47], v[88:91], v[96:99], v[44:47]
    v_mfma_f32_16x16x32_bf16 v[48:51], v[88:91], v[100:103], v[48:51]
    v_mfma_f32_16x16x32_bf16 v[48:51], v[92:95], v[96:99], v[48:51]
    s_waitcnt lgkmcnt(0)
    v_mfma_f32_16x16x32_bf16 v[20:23], v[128:131], v[160:163], v[20:23]
    ds_read_b64 v[192:193], v12 offset:32
    v_mfma_f32_16x16x32_bf16 v[24:27], v[128:131], v[164:167], v[24:27]
    ds_read_b64 v[194:195], v12 offset:544
    v_mfma_f32_16x16x32_bf16 v[28:31], v[128:131], v[168:171], v[28:31]
    ds_read_b64 v[196:197], v12 offset:1056
    v_mfma_f32_16x16x32_bf16 v[32:35], v[128:131], v[172:175], v[32:35]
    ds_read_b64 v[198:199], v12 offset:1568
    v_mfma_f32_16x16x32_bf16 v[36:39], v[128:131], v[176:179], v[36:39]
    v_mfma_f32_16x16x32_bf16 v[40:43], v[128:131], v[180:183], v[40:43]
    v_mfma_f32_16x16x32_bf16 v[44:47], v[128:131], v[184:187], v[44:47]
    v_mfma_f32_16x16x32_bf16 v[48:51], v[128:131], v[188:191], v[48:51]
    v_mfma_f32_16x16x32_bf16 v[24:27], v[132:135], v[160:163], v[24:27]
    v_mfma_f32_16x16x32_bf16 v[28:31], v[132:135], v[164:167], v[28:31]
    v_mfma_f32_16x16x32_bf16 v[32:35], v[132:135], v[168:171], v[32:35]
    v_mfma_f32_16x16x32_bf16 v[36:39], v[132:135], v[172:175], v[36:39]
    v_mfma_f32_16x16x32_bf16 v[40:43], v[132:135], v[176:179], v[40:43]
    v_mfma_f32_16x16x32_bf16 v[44:47], v[132:135], v[180:183], v[44:47]
    v_mfma_f32_16x16x32_bf16 v[48:51], v[132:135], v[184:187], v[48:51]
    v_mfma_f32_16x16x32_bf16 v[28:31], v[136:139], v[160:163], v[28:31]
    v_mfma_f32_16x16x32_bf16 v[32:35], v[136:139], v[164:167], v[32:35]
    v_mfma_f32_16x16x32_bf16 v[36:39], v[136:139], v[168:171], v[36:39]
    v_mfma_f32_16x16x32_bf16 v[40:43], v[136:139], v[172:175], v[40:43]
    v_mfma_f32_16x16x32_bf16 v[44:47], v[136:139], v[176:179], v[44:47]
    v_mfma_f32_16x16x32_bf16 v[48:51], v[136:139], v[180:183], v[48:51]
    v_mfma_f32_16x16x32_bf16 v[32:35], v[140:143], v[160:163], v[32:35]
    v_mfma_f32_16x16x32_bf16 v[36:39], v[140:143], v[164:167], v[36:39]
    v_mfma_f32_16x16x32_bf16 v[40:43], v[140:143], v[168:171], v[40:43]
    v_mfma_f32_16x16x32_bf16 v[44:47], v[140:143], v[172:175], v[44:47]
    v_mfma_f32_16x16x32_bf16 v[48:51], v[140:143], v[176:179], v[48:51]
    v_mfma_f32_16x16x32_bf16 v[36:39], v[144:147], v[160:163], v[36:39]
    v_mfma_f32_16x16x32_bf16 v[40:43], v[144:147], v[164:167], v[40:43]
    v_mfma_f32_16x16x32_bf16 v[44:47], v[144:147], v[168:171], v[44:47]
    v_mfma_f32_16x16x32_bf16 v[48:51], v[144:147], v[172:175], v[48:51]
    v_mfma_f32_16x16x32_bf16 v[40:43], v[148:151], v[160:163], v[40:43]
    v_mfma_f32_16x16x32_bf16 v[44:47], v[148:151], v[164:167], v[44:47]
    v_mfma_f32_16x16x32_bf16 v[48:51], v[148:151], v[168:171], v[48:51]
    v_mfma_f32_16x16x32_bf16 v[44:47], v[152:155], v[160:163], v[44:47]
    v_mfma_f32_16x16x32_bf16 v[48:51], v[152:155], v[164:167], v[48:51]
    v_mfma_f32_16x16x32_bf16 v[48:51], v[156:159], v[160:163], v[48:51]
    s_setprio 3
    s_waitcnt lgkmcnt(0)
    v_lshlrev_b32 v96, 16, v192
    v_and_b32 v97, 0xffff0000, v192
    v_lshlrev_b32 v98, 16, v193
    v_and_b32 v99, 0xffff0000, v193
    v_lshlrev_b32 v100, 16, v194
    v_and_b32 v101, 0xffff0000, v194
    v_lshlrev_b32 v102, 16, v195
    v_and_b32 v103, 0xffff0000, v195
    v_lshlrev_b32 v104, 16, v196
    v_and_b32 v105, 0xffff0000, v196
    v_lshlrev_b32 v106, 16, v197
    v_and_b32 v107, 0xffff0000, v197
    v_lshlrev_b32 v108, 16, v198
    v_and_b32 v109, 0xffff0000, v198
    v_lshlrev_b32 v110, 16, v199
    v_and_b32 v111, 0xffff0000, v199
    s_cmp_eq_u32 s62, 0
    s_cbranch_scc1 L_even2
    ds_write_b128 v8, v[20:23] offset:0
    ds_write_b128 v8, v[24:27] offset:1024
    ds_write_b128 v8, v[28:31] offset:2048
    ds_write_b128 v8, v[32:35] offset:3072
    v_fma_f32 v96, s94, v96, v36
    v_fma_f32 v97, s94, v97, v37
    v_fma_f32 v98, s94, v98, v38
    v_fma_f32 v99, s94, v99, v39
    v_fma_f32 v100, s94, v100, v40
    v_fma_f32 v101, s94, v101, v41
    v_fma_f32 v102, s94, v102, v42
    v_fma_f32 v103, s94, v103, v43
    v_fma_f32 v104, s94, v104, v44
    v_fma_f32 v105, s94, v105, v45
    v_fma_f32 v106, s94, v106, v46
    v_fma_f32 v107, s94, v107, v47
    v_fma_f32 v108, s94, v108, v48
    v_fma_f32 v109, s94, v109, v49
    v_fma_f32 v110, s94, v110, v50
    v_fma_f32 v111, s94, v111, v51
    s_branch L_join2
L_even2:
    ds_write_b128 v8, v[36:39] offset:0
    ds_write_b128 v8, v[40:43] offset:1024
    ds_write_b128 v8, v[44:47] offset:2048
    ds_write_b128 v8, v[48:51] offset:3072
    v_fma_f32 v96, s94, v96, v20
    v_fma_f32 v97, s94, v97, v21
    v_fma_f32 v98, s94, v98, v22
    v_fma_f32 v99, s94, v99, v23
    v_fma_f32 v100, s94, v100, v24
    v_fma_f32 v101, s94, v101, v25
    v_fma_f32 v102, s94, v102, v26
    v_fma_f32 v103, s94, v103, v27
    v_fma_f32 v104, s94, v104, v28
    v_fma_f32 v105, s94, v105, v29
    v_fma_f32 v106, s94, v106, v30
    v_fma_f32 v107, s94, v107, v31
    v_fma_f32 v108, s94, v108, v32
    v_fma_f32 v109, s94, v109, v33
    v_fma_f32 v110, s94, v110, v34
    v_fma_f32 v111, s94, v111, v35
L_join2:
    s_waitcnt lgkmcnt(0)
    s_barrier
    ds_read_b128 v[64:67], v9 offset:0
    ds_read_b128 v[68:71], v9 offset:1024
    ds_read_b128 v[72:75], v9 offset:2048
    ds_read_b128 v[76:79], v9 offset:3072
    s_waitcnt lgkmcnt(3)
    v_add_f32 v96, v96, v64
    v_add_f32 v97, v97, v65
    v_add_f32 v98, v98, v66
    v_add_f32 v99, v99, v67
    v_cvt_pk_bf16_f32 v80, v96, v97
    v_cvt_pk_bf16_f32 v81, v98, v99
    s_waitcnt lgkmcnt(2)
    v_add_f32 v100, v100, v68
    v_add_f32 v101, v101, v69
    v_add_f32 v102, v102, v70
    v_add_f32_e64 v103, v103, v71
    v_cvt_pk_bf16_f32 v82, v100, v101
    v_cvt_pk_bf16_f32 v83, v102, v103
    s_waitcnt lgkmcnt(1)
    v_add_f32 v104, v104, v72
    v_add_f32 v105, v105, v73
    v_add_f32 v106, v106, v74
    v_add_f32_e64 v107, v107, v75
    v_cvt_pk_bf16_f32 v84, v104, v105
    v_cvt_pk_bf16_f32 v85, v106, v107
    s_waitcnt lgkmcnt(0)
    v_add_f32 v108, v108, v76
    v_add_f32 v109, v109, v77
    v_add_f32 v110, v110, v78
    v_add_f32_e64 v111, v111, v79
    v_cvt_pk_bf16_f32 v86, v108, v109
    v_cvt_pk_bf16_f32 v87, v110, v111
    ds_write_b64 v11, v[80:81] offset:0
    ds_write_b64 v11, v[82:83] offset:512
    ds_write_b64 v11, v[84:85] offset:1024
    ds_write_b64 v11, v[86:87] offset:1536
    ds_read_b128 v[88:91], v8 offset:16384
    ds_read_b128 v[92:95], v8 offset:17408
    s_waitcnt lgkmcnt(1)
    buffer_store_dwordx4 v[88:91], v4, s[52:55], s74 offen offset:0 sc1
    s_waitcnt lgkmcnt(0)
    buffer_store_dwordx4 v[92:95], v4, s[52:55], s74 offen offset:1024 sc1
    s_waitcnt vmcnt(0)
    s_barrier
    buffer_store_dword v5, v15, s[52:55], 0 offen sc1
    s_endpgm
L_aux:
    s_lshl_b32 s72, s64, 2
    s_add_u32 s83, s72, s60
    s_mul_i32 s74, s83, 14336
    s_lshl_b32 s84, s60, 11
    v_lshlrev_b32 v1, 4, v0
    v_lshrrev_b32 v10, 3, v0
    v_and_b32 v11, 7, v0
    v_lshlrev_b32 v12, 4, v11
    v_mul_u32_u24 v2, 896, v10
    v_add_u32 v2, v2, v12
    v_add_u32 v3, 6144, v2
    s_waitcnt lgkmcnt(0)
    s_load_dword s63, s[36:37], 0
    s_mov_b32 s40, s4
    s_mov_b32 s41, s5
    s_mov_b32 s42, 1835008
    s_mov_b32 s43, 0x20000
    s_mov_b32 s44, s30
    s_mov_b32 s45, s31
    s_mov_b32 s46, 896
    s_mov_b32 s47, 0x20000
    s_add_u32 m0, s84, 0
    s_nop 0
    buffer_load_dwordx4 v2, s[40:43], s74 offen lds
    buffer_load_dwordx4 v3, s[40:43], s74 offen offset:1024 lds
    s_add_u32 m0, s84, 8192
    s_add_u32 s74, s74, 128
    buffer_load_dwordx4 v2, s[40:43], s74 offen lds
    buffer_load_dwordx4 v3, s[40:43], s74 offen offset:1024 lds
    s_add_u32 m0, s84, 16384
    s_add_u32 s74, s74, 128
    buffer_load_dwordx4 v2, s[40:43], s74 offen lds
    buffer_load_dwordx4 v3, s[40:43], s74 offen offset:1024 lds
    s_add_u32 m0, s84, 24576
    s_add_u32 s74, s74, 128
    buffer_load_dwordx4 v2, s[40:43], s74 offen lds
    buffer_load_dwordx4 v3, s[40:43], s74 offen offset:1024 lds
    s_add_u32 m0, s84, 32768
    s_add_u32 s74, s74, 128
    buffer_load_dwordx4 v2, s[40:43], s74 offen lds
    buffer_load_dwordx4 v3, s[40:43], s74 offen offset:1024 lds
    s_add_u32 m0, s84, 40960
    s_add_u32 s74, s74, 128
    buffer_load_dwordx4 v2, s[40:43], s74 offen lds
    buffer_load_dwordx4 v3, s[40:43], s74 offen offset:1024 lds
    s_add_u32 m0, s84, 49152
    s_add_u32 s74, s74, 128
    buffer_load_dwordx4 v2, s[40:43], s74 offen lds
    buffer_load_dwordx4 v3, s[40:43], s74 offen offset:1024 lds
    buffer_load_dwordx4 v[112:115], v12, s[44:47], 0 offen offset:0
    buffer_load_dwordx4 v[116:119], v12, s[44:47], 0 offen offset:128
    buffer_load_dwordx4 v[120:123], v12, s[44:47], 0 offen offset:256
    buffer_load_dwordx4 v[124:127], v12, s[44:47], 0 offen offset:384
    buffer_load_dwordx4 v[128:131], v12, s[44:47], 0 offen offset:512
    buffer_load_dwordx4 v[132:135], v12, s[44:47], 0 offen offset:640
    buffer_load_dwordx4 v[136:139], v12, s[44:47], 0 offen offset:768
    s_mov_b32 s52, s36
    s_mov_b32 s53, s37
    s_mov_b32 s54, 16777216
    s_mov_b32 s55, 0x20000
    s_mov_b32 s48, s28
    s_mov_b32 s49, s29
    s_mov_b32 s50, 1605632
    s_mov_b32 s51, 0x20000
    s_lshl_b32 s72, s83, 11
    s_add_u32 s72, s72, 65536
    buffer_load_dwordx4 v[100:103], v1, s[52:55], s72 offen sc1
    buffer_load_dwordx4 v[100:103], v1, s[52:55], s72 offen offset:1024 sc1
    v_add_u32 v13, s84, v1
    s_waitcnt lgkmcnt(0)
    s_mul_i32 s63, s63, 0x9E3779B1
    s_add_u32 s63, s63, 0x7F4A7C15
    s_mov_b32 s88, s63
    s_mov_b32 s89, s63
    v_mov_b32 v19, s63
    s_cmp_lt_u32 s60, 2
    s_cselect_b32 s68, s24, s26
    s_cselect_b32 s69, s25, s27
    s_mov_b32 s70, 1605632
    s_mov_b32 s71, 0x20000
    v_lshrrev_b32 v7, 3, v0
    v_mul_u32_u24 v7, 3584, v7
    v_and_b32 v6, 7, v0
    v_lshl_add_u32 v7, v6, 4, v7
    s_and_b32 s72, s66, 3
    s_lshl_b32 s72, s72, 3
    s_lshr_b32 s80, 0x05030100, s72
    s_and_b32 s80, s80, 7
    s_lshl_b32 s80, s80, 8
    s_lshr_b32 s73, 0x08182800, s72
    s_and_b32 s73, s73, 63
    s_and_b32 s78, s67, 3
    s_lshl_b32 s78, s78, 1
    s_and_b32 s72, s60, 1
    s_add_u32 s78, s78, s72
    s_add_u32 s78, s78, s73
    s_mul_i32 s78, s78, 28672
    s_lshr_b32 s72, s66, 2
    s_mul_i32 s81, s72, 1792
    s_add_u32 s81, s81, 128
    s_mov_b32 s79, 0
L_pw24:
    s_add_u32 s74, s80, s78
    s_add_u32 s74, s74, s81
    s_waitcnt vmcnt(9)
    buffer_load_dwordx4 v[100:103], v7, s[68:71], s74 offen
    s_add_u32 s78, s78, 229376
    s_cmp_lt_u32 s78, 1605632
    s_cbranch_scc1 L_pn25
    s_sub_u32 s78, s78, 1605632
    s_add_u32 s72, s80, 256
    s_sub_u32 s73, s72, 1792
    s_cselect_b32 s80, s72, s73
L_pn25:
    s_add_u32 s79, s79, 1
    s_cmp_lt_u32 s79, 13
    s_cbranch_scc1 L_pw24
    ds_read_b128 v[32:35], v13 offset:0
    ds_read_b128 v[36:39], v13 offset:1024
    ds_read_b128 v[40:43], v13 offset:8192
    ds_read_b128 v[44:47], v13 offset:9216
    ds_read_b128 v[48:51], v13 offset:16384
    ds_read_b128 v[52:55], v13 offset:17408
    ds_read_b128 v[56:59], v13 offset:24576
    ds_read_b128 v[60:63], v13 offset:25600
    ds_read_b128 v[64:67], v13 offset:32768
    ds_read_b128 v[68:71], v13 offset:33792
    ds_read_b128 v[72:75], v13 offset:40960
    ds_read_b128 v[76:79], v13 offset:41984
    ds_read_b128 v[80:83], v13 offset:49152
    ds_read_b128 v[84:87], v13 offset:50176
    s_waitcnt lgkmcnt(0)
    v_dot2_f32_bf16 v24, v32, v112, 0
    v_dot2_f32_bf16 v25, v36, v112, 0
    v_dot2_f32_bf16 v24, v33, v113, v24
    v_dot2_f32_bf16 v25, v37, v113, v25
    v_dot2_f32_bf16 v24, v34, v114, v24
    v_dot2_f32_bf16 v25, v38, v114, v25
    v_dot2_f32_bf16 v24, v35, v115, v24
    v_dot2_f32_bf16 v25, v39, v115, v25
    v_dot2_f32_bf16 v24, v40, v116, v24
    v_dot2_f32_bf16 v25, v44, v116, v25
    v_dot2_f32_bf16 v24, v41, v117, v24
    v_dot2_f32_bf16 v25, v45, v117, v25
    v_dot2_f32_bf16 v24, v42, v118, v24
    v_dot2_f32_bf16 v25, v46, v118, v25
    v_dot2_f32_bf16 v24, v43, v119, v24
    v_dot2_f32_bf16 v25, v47, v119, v25
    v_dot2_f32_bf16 v24, v48, v120, v24
    v_dot2_f32_bf16 v25, v52, v120, v25
    v_dot2_f32_bf16 v24, v49, v121, v24
    v_dot2_f32_bf16 v25, v53, v121, v25
    v_dot2_f32_bf16 v24, v50, v122, v24
    v_dot2_f32_bf16 v25, v54, v122, v25
    v_dot2_f32_bf16 v24, v51, v123, v24
    v_dot2_f32_bf16 v25, v55, v123, v25
    v_dot2_f32_bf16 v24, v56, v124, v24
    v_dot2_f32_bf16 v25, v60, v124, v25
    v_dot2_f32_bf16 v24, v57, v125, v24
    v_dot2_f32_bf16 v25, v61, v125, v25
    v_dot2_f32_bf16 v24, v58, v126, v24
    v_dot2_f32_bf16 v25, v62, v126, v25
    v_dot2_f32_bf16 v24, v59, v127, v24
    v_dot2_f32_bf16 v25, v63, v127, v25
    v_dot2_f32_bf16 v24, v64, v128, v24
    v_dot2_f32_bf16 v25, v68, v128, v25
    v_dot2_f32_bf16 v24, v65, v129, v24
    v_dot2_f32_bf16 v25, v69, v129, v25
    v_dot2_f32_bf16 v24, v66, v130, v24
    v_dot2_f32_bf16 v25, v70, v130, v25
    v_dot2_f32_bf16 v24, v67, v131, v24
    v_dot2_f32_bf16 v25, v71, v131, v25
    v_dot2_f32_bf16 v24, v72, v132, v24
    v_dot2_f32_bf16 v25, v76, v132, v25
    v_dot2_f32_bf16 v24, v73, v133, v24
    v_dot2_f32_bf16 v25, v77, v133, v25
    v_dot2_f32_bf16 v24, v74, v134, v24
    v_dot2_f32_bf16 v25, v78, v134, v25
    v_dot2_f32_bf16 v24, v75, v135, v24
    v_dot2_f32_bf16 v25, v79, v135, v25
    v_dot2_f32_bf16 v24, v80, v136, v24
    v_dot2_f32_bf16 v25, v84, v136, v25
    v_dot2_f32_bf16 v24, v81, v137, v24
    v_dot2_f32_bf16 v25, v85, v137, v25
    v_dot2_f32_bf16 v24, v82, v138, v24
    v_dot2_f32_bf16 v25, v86, v138, v25
    v_dot2_f32_bf16 v24, v83, v139, v24
    v_dot2_f32_bf16 v25, v87, v139, v25
    s_nop 2
    v_add_f32_dpp v24, v24, v24 row_shr:1 row_mask:0xf bank_mask:0xf bound_ctrl:0
    v_add_f32_dpp v25, v25, v25 row_shr:1 row_mask:0xf bank_mask:0xf bound_ctrl:0
    s_nop 0
    v_add_f32_dpp v24, v24, v24 row_shr:2 row_mask:0xf bank_mask:0xf bound_ctrl:0
    v_add_f32_dpp v25, v25, v25 row_shr:2 row_mask:0xf bank_mask:0xf bound_ctrl:0
    s_nop 0
    v_add_f32_dpp v24, v24, v24 row_shr:4 row_mask:0xf bank_mask:0xf bound_ctrl:0
    v_add_f32_dpp v25, v25, v25 row_shr:4 row_mask:0xf bank_mask:0xf bound_ctrl:0
    v_cvt_pk_bf16_f32 v26, v24, v25
    v_lshlrev_b32 v24, 16, v26
    v_and_b32 v25, 0xffff0000, v26
    v_mul_f32 v24, 3216550459, v24
    v_mul_f32 v25, 3216550459, v25
    v_exp_f32 v24, v24
    v_exp_f32 v25, v25
    v_add_f32 v24, 1.0, v24
    v_add_f32 v25, 1.0, v25
    v_rcp_f32 v24, v24
    v_rcp_f32 v25, v25
    s_nop 0
    v_cvt_pk_bf16_f32 v26, v24, v25
    v_lshlrev_b32 v24, 16, v26
    v_and_b32 v25, 0xffff0000, v26
    v_sub_f32 v26, 1.0, v24
    v_sub_f32 v27, 1.0, v25
    v_cvt_pk_bf16_f32 v28, v24, v26
    v_cvt_pk_bf16_f32 v30, v25, v27
    v_mov_b32 v29, v19
    v_mov_b32 v31, v19
    v_lshlrev_b32_e64 v24, 3, v10
    v_cmp_eq_u32 vcc, 7, v11
    s_nop 1
    v_cndmask_b32 v24, 2.0, v24, vcc
    s_lshl_b32 s72, s83, 7
    s_add_u32 s72, s72, 32768
    buffer_store_dwordx2 v[28:29], v24, s[52:55], s72 offen sc1
    buffer_store_dwordx2 v[30:31], v24, s[52:55], s72 offen offset:64 sc1
    s_and_b32 s80, s67, 3
    s_lshl_b32 s80, s80, 2
    s_add_u32 s80, s80, s60
    s_lshl_b32 s78, s66, 4
    s_add_u32 s78, s78, s80
    s_mov_b32 s79, 0
L_pf26:
    s_mul_i32 s72, s78, 18725
    s_lshr_b32 s72, s72, 20
    s_mul_i32 s72, s72, 56
    s_add_u32 s74, s78, s72
    s_cmp_ge_u32 s78, 784
    s_cselect_b32 s73, 1512, 0
    s_sub_u32 s74, s74, s73
    s_lshl_b32 s74, s74, 10
    s_waitcnt vmcnt(9)
    buffer_load_dwordx4 v[100:103], v1, s[48:51], s74 offen
    s_add_u32 s78, s78, 128
    s_add_u32 s79, s79, 1
    s_cmp_lt_u32 s79, 13
    s_cbranch_scc1 L_pf26
    s_add_u32 s78, s80, 784
    s_mov_b32 s79, 0
L_pf27:
    s_mul_i32 s72, s78, 18725
    s_lshr_b32 s72, s72, 20
    s_mul_i32 s72, s72, 56
    s_add_u32 s74, s78, s72
    s_cmp_ge_u32 s78, 784
    s_cselect_b32 s73, 1512, 0
    s_sub_u32 s74, s74, s73
    s_lshl_b32 s74, s74, 10
    s_waitcnt vmcnt(9)
    buffer_load_dwordx4 v[100:103], v1, s[48:51], s74 offen
    s_add_u32 s78, s78, 16
    s_add_u32 s79, s79, 1
    s_cmp_lt_u32 s79, 49
    s_cbranch_scc1 L_pf27
    s_cmp_lg_u32 s2, 224
    s_cbranch_scc1 L_end
    s_cmp_lg_u32 s60, 0
    s_cbranch_scc1 L_end
    s_mov_b32 s86, 0
    v_and_b32 v1, 15, v0
    v_min_u32 v1, 13, v1
    v_lshrrev_b32 v2, 4, v0
    v_lshlrev_b32 v2, 8, v2
    v_lshl_add_u32 v1, v1, 2, v2
    v_lshlrev_b32 v2, 7, v0
    v_add_u32 v2, 4, v2
    v_and_b32 v3, 31, v0
    v_lshrrev_b32 v4, 5, v0
    v_lshlrev_b32_e64 v4, 12, v4
    v_lshl_add_u32 v3, v3, 2, v4
L_upd:
    s_mov_b32 s72, 159744
    buffer_load_dword v40, v1, s[52:55], s72 offen offset:0 sc1
    buffer_load_dword v41, v1, s[52:55], s72 offen offset:1024 sc1
    buffer_load_dword v42, v1, s[52:55], s72 offen offset:2048 sc1
    buffer_load_dword v43, v1, s[52:55], s72 offen offset:3072 sc1
    s_mov_b32 s72, 32768
    buffer_load_dword v44, v2, s[52:55], s72 offen sc1
    s_mov_b32 s72, 40960
    buffer_load_dword v45, v2, s[52:55], s72 offen sc1
    s_mov_b32 s72, 65536
    buffer_load_dword v46, v3, s[52:55], s72 offen sc1
    s_mov_b32 s72, 73728
    buffer_load_dword v47, v3, s[52:55], s72 offen sc1
    s_mov_b32 s72, 81920
    buffer_load_dword v48, v3, s[52:55], s72 offen sc1
    s_mov_b32 s72, 86016
    buffer_load_dword v49, v3, s[52:55], s72 offen sc1
    s_waitcnt vmcnt(0)
    v_mov_b32 v5, 0
    v_xor_b32 v6, s63, v40
    v_or_b32 v5, v5, v6
    v_xor_b32 v6, s63, v41
    v_or_b32 v5, v5, v6
    v_xor_b32 v6, s63, v42
    v_or_b32 v5, v5, v6
    v_xor_b32 v6, s63, v43
    v_or_b32 v5, v5, v6
    v_xor_b32 v6, s63, v44
    v_or_b32 v5, v5, v6
    v_xor_b32 v6, s63, v45
    v_or_b32 v5, v5, v6
    v_xor_b32 v6, s63, v46
    v_or_b32 v5, v5, v6
    v_xor_b32 v6, s63, v47
    v_or_b32 v5, v5, v6
    v_xor_b32 v6, s63, v48
    v_or_b32 v5, v5, v6
    v_xor_b32 v6, s63, v49
    v_or_b32 v5, v5, v6
    v_cmp_ne_u32 vcc, 0, v5
    s_nop 4
    s_cbranch_vccz L_upd_ok
    s_add_u32 s86, s86, 1
    s_cmp_ge_u32 s86, 20000
    s_cbranch_scc1 L_upd_ok
    s_sleep 8
    s_branch L_upd
L_upd_ok:
    v_mov_b32 v3, 2.0
    v_writelane_b32 v3, 0, 0
    v_mov_b32 v4, s63
    buffer_store_dword v4, v3, s[52:55], 0 offen sc1
    s_endpgm
L_end:
    s_endpgm
.section .rodata,"a"
.p2align 6
.amdhsa_kernel gated_mix__ssm_conv_s4__swiglu_ffn__prompt_kernel
  .amdhsa_next_free_vgpr 256
  .amdhsa_next_free_sgpr 102
  .amdhsa_accum_offset 256
  .amdhsa_group_segment_fixed_size 0
  .amdhsa_kernarg_size 136
  .amdhsa_user_sgpr_count 2
  .amdhsa_user_sgpr_kernarg_segment_ptr 1
  .amdhsa_system_sgpr_workgroup_id_x 1
.end_amdhsa_kernel
```
